```python
import torch

def _softmax(x, axis=-1):
    return torch.softmax(x, dim=axis)
def _gelu(x):
    return torch.nn.functional.gelu(x, approximate="tanh")
def _silu(x):
    return torch.nn.functional.silu(x)
def _sigmoid(x):
    return torch.sigmoid(x)
def _layernorm(x, axis=-1, eps=1e-5):
    m = x.mean(dim=axis, keepdim=True)
    v = x.var(dim=axis, keepdim=True, unbiased=False)
    return (x - m) / torch.sqrt(v + eps)
def _scatter_add(tgt, idx, src, axis=0):
    return tgt.clone().index_add_(axis, idx, src)
def _segment_sum(src, seg, n):
    out = torch.zeros((n,) + src.shape[1:], dtype=src.dtype)
    return out.index_add_(0, seg, src)
def _pad(x, pw):
    flat = tuple(v for pair in reversed(pw) for v in pair)
    return torch.nn.functional.pad(x, flat)

kernel_name = 'concat_heads__sliding_block_cached__sliding_block_cached__decode'

def setup_inputs():

    _w = (lambda a: (lambda t: t.to(torch.bfloat16) if t.is_floating_point() else t)(torch.as_tensor(a)))
    def _A_setup():
        B, Sq, D = 2, 1, 512
        Hq, Hkv, Sk, Dh = 32, 32, 8192, 128
        assert Hq % Hkv == 0, (Hq, Hkv)
        return {
            "x": _w((lambda *s: torch.randn(*s, dtype=torch.bfloat16) * 0.8)(B, Sq, D)),
            "k_cache": _w((lambda *s: torch.randn(*s, dtype=torch.bfloat16) * 1.6)(B, Hkv, Sk, Dh)),
            "v_cache": _w((lambda *s: torch.randn(*s, dtype=torch.bfloat16) * 0.2)(B, Hkv, Sk, Dh)),
            "wq": _w((lambda *s: torch.randn(*s, dtype=torch.bfloat16) * 1.6)(D, Hq * Dh) * (D ** -0.5)),
            "wo": _w((lambda *s: torch.randn(*s, dtype=torch.bfloat16) * 0.2)(Hq * Dh, D) * ((Hq * Dh) ** -0.5)),
        }
    _A_in = _A_setup()

    def _B_setup():
        B, Sq, D = 2, 1, 512
        Hq, Hkv, Sk, Dh = 32, 32, 8192, 128
        assert Hq % Hkv == 0, (Hq, Hkv)
        return {
            "x": _w((lambda *s: torch.randn(*s, dtype=torch.bfloat16) * 0.8)(B, Sq, D)),
            "k_cache": _w((lambda *s: torch.randn(*s, dtype=torch.bfloat16) * 1.6)(B, Hkv, Sk, Dh)),
            "v_cache": _w((lambda *s: torch.randn(*s, dtype=torch.bfloat16) * 0.2)(B, Hkv, Sk, Dh)),
            "wq": _w((lambda *s: torch.randn(*s, dtype=torch.bfloat16) * 1.6)(D, Hq * Dh) * (D ** -0.5)),
            "wo": _w((lambda *s: torch.randn(*s, dtype=torch.bfloat16) * 0.2)(Hq * Dh, D) * ((Hq * Dh) ** -0.5)),
        }
    _B_in = _B_setup()

    return {
        "A_x": _A_in["x"],
        "A_k_cache": _A_in["k_cache"],
        "A_v_cache": _A_in["v_cache"],
        "A_wq": _A_in["wq"],
        "A_wo": _A_in["wo"],
        "B_x": _B_in["x"],
        "B_k_cache": _B_in["k_cache"],
        "B_v_cache": _B_in["v_cache"],
        "B_wq": _B_in["wq"],
        "B_wo": _B_in["wo"],
    }

def reference(A_x, A_k_cache, A_v_cache, A_wq, A_wo, B_x, B_k_cache, B_v_cache, B_wq, B_wo):
    def _A_ref(x, k_cache, v_cache, wq, wo):
        B, Sq, D = x.shape
        Hq, Dh = 32, 128
        Hkv, Sk = k_cache.shape[1], k_cache.shape[2]
        W = min(4096, max(256, Sk // 4))
        rep = Hq // Hkv
        q = (lambda x, *d: x.permute(*d))((x @ wq).reshape(B, Sq, Hq, Dh), 0, 2, 1, 3)
        k = (lambda x, n, axis: torch.repeat_interleave(x, n, dim=axis))(k_cache[:, :, Sk - W:, :], rep, axis=1)
        v = (lambda x, n, axis: torch.repeat_interleave(x, n, dim=axis))(v_cache[:, :, Sk - W:, :], rep, axis=1)
        scores = torch.einsum("bhqd,bhkd->bhqk", q, k) * (Dh ** -0.5)
        p = _softmax(scores, axis=-1)
        o = torch.einsum("bhqk,bhkd->bhqd", p, v)
        return (lambda x, *d: x.permute(*d))(o, 0, 2, 1, 3).reshape(B, Sq, Hq * Dh) @ wo

    def _B_ref(x, k_cache, v_cache, wq, wo):
        B, Sq, D = x.shape
        Hq, Dh = 32, 128
        Hkv, Sk = k_cache.shape[1], k_cache.shape[2]
        W = min(4096, max(256, Sk // 4))
        rep = Hq // Hkv
        q = (lambda x, *d: x.permute(*d))((x @ wq).reshape(B, Sq, Hq, Dh), 0, 2, 1, 3)
        k = (lambda x, n, axis: torch.repeat_interleave(x, n, dim=axis))(k_cache[:, :, Sk - W:, :], rep, axis=1)
        v = (lambda x, n, axis: torch.repeat_interleave(x, n, dim=axis))(v_cache[:, :, Sk - W:, :], rep, axis=1)
        scores = torch.einsum("bhqd,bhkd->bhqk", q, k) * (Dh ** -0.5)
        p = _softmax(scores, axis=-1)
        o = torch.einsum("bhqk,bhkd->bhqd", p, v)
        return (lambda x, *d: x.permute(*d))(o, 0, 2, 1, 3).reshape(B, Sq, Hq * Dh) @ wo

    a = _A_ref(A_x, A_k_cache, A_v_cache, A_wq, A_wo)
    b = _B_ref(B_x, B_k_cache, B_v_cache, B_wq, B_wo)
    return torch.concatenate([a, b], axis=-1)
```

```asm
; @launch grid=(256,1,1) block=(512,1,1) lds=139264
.amdgcn_target "amdgcn-amd-amdhsa--gfx950"
.text
.globl concat_heads__sliding_block_cached__sliding_block_cached__decode_kernel
.p2align 8
.type concat_heads__sliding_block_cached__sliding_block_cached__decode_kernel,@function
concat_heads__sliding_block_cached__sliding_block_cached__decode_kernel:
    s_cmp_ge_u32 s2, 256
    s_cbranch_scc1 L_end
    s_bfe_u32 s61, s2, 0x10002
    s_mul_i32 s26, s61, 40
    s_load_dwordx8 s[8:15], s[0:1], s26
    s_and_b32 s62, s2, 3
    s_lshr_b32 s60, s2, 5
    s_lshl3_add_u32 s62, s62, s60
    v_lshrrev_b32 v7, 6, v0
    v_lshlrev_b32 v4, 4, v0
    s_movk_i32 s4, 3072
    v_mad_u32_u24 v4, v7, s4, v4
    s_lshr_b32 s65, s2, 3
    s_and_b32 s64, s65, 1
    s_and_b32 s18, s2, 16
    s_lshl1_add_u32 s18, s18, s62
    s_lshl3_add_u32 s18, s18, s64
    s_add_u32 s18, s18, 6
    s_lshl_b32 s18, s18, 18
    s_mov_b32 s31, 0x20000
    s_lshl_b32 s30, s31, 1
    s_and_b32 s66, s65, 7
    s_lshl_b32 s66, s66, 15
    s_add_u32 s67, s65, 1
    s_and_b32 s67, s67, 7
    s_lshl_b32 s67, s67, 15
    s_waitcnt lgkmcnt(0)
    s_add_u32 s28, s10, s18
    s_addc_u32 s29, s11, 0
    buffer_load_dwordx4 v[68:71], v4, s[28:31], s66 offen offset:0 nt
    buffer_load_dwordx4 v[72:75], v4, s[28:31], s66 offen offset:1024 nt
    buffer_load_dwordx4 v[76:79], v4, s[28:31], s66 offen offset:2048 nt
    buffer_load_dwordx4 v[80:83], v4, s[28:31], s66 offen offset:3072 nt
    s_load_dwordx2 s[16:17], s[0:1], s26 offset:32
    s_load_dwordx4 s[20:23], s[0:1], 80
    s_load_dwordx2 s[24:25], s[0:1], 96
    v_and_b32 v2, 15, v0
    v_bfe_u32 v3, v0, 4, 2
    v_lshlrev_b32 v5, 4, v2
    v_lshl_add_u32 v5, v3, 17, v5
    v_lshl_add_u32 v5, v7, 19, v5
    s_lshl_b32 s19, s62, 8
    s_sub_u32 s38, 0x400000, s19
    s_mov_b32 s39, s31
    s_and_b32 s74, s65, 3
    s_lshl_b32 s74, s74, 12
    s_add_u32 s36, s14, s19
    s_addc_u32 s37, s15, 0
    s_lshl_b32 s81, s74, 3
    buffer_load_dwordx4 v[84:87], v5, s[36:39], s81 offen
    s_add_u32 s81, s81, 0x2000
    buffer_load_dwordx4 v[88:91], v5, s[36:39], s81 offen
    s_add_u32 s81, s81, 0x2000
    buffer_load_dwordx4 v[92:95], v5, s[36:39], s81 offen
    s_add_u32 s81, s81, 0x2000
    buffer_load_dwordx4 v[96:99], v5, s[36:39], s81 offen
    s_mov_b32 s4, 0x8000
    s_mov_b32 s5, 0x38000
    s_add_u32 s68, s67, s4
    s_and_b32 s68, s68, s5
    s_add_u32 s69, s68, s4
    s_and_b32 s69, s69, s5
    s_add_u32 s70, s69, s4
    s_and_b32 s70, s70, s5
    s_add_u32 s71, s70, s4
    s_and_b32 s71, s71, s5
    s_add_u32 s72, s71, s4
    s_and_b32 s72, s72, s5
    s_add_u32 s73, s72, s4
    s_and_b32 s73, s73, s5
    s_movk_i32 s4, 0x1000
    s_movk_i32 s5, 0x3000
    s_add_u32 s75, s74, s4
    s_and_b32 s75, s75, s5
    s_add_u32 s76, s75, s4
    s_and_b32 s76, s76, s5
    s_add_u32 s77, s76, s4
    s_and_b32 s77, s77, s5
    s_and_b32 s4, s62, 3
    s_cmp_eq_u32 s4, 1
    s_cbranch_scc1 M_alt
    v_readfirstlane_b32 s3, v7
    s_bfe_u32 s63, s2, 0x10004
    s_mov_b32 s50, 0x1000000
    s_mov_b32 s51, s31
    s_lshl1_add_u32 s7, s61, s63
    s_lshl1_add_u32 s78, s62, s64
    s_lshl_b32 s80, s7, 6
    s_add_u32 s80, s80, s78
    s_and_b32 s83, s80, 127
    s_andn2_b32 s79, s83, 3
    s_add_u32 s79, s79, s83
    s_lshl2_add_u32 s79, s61, s79
    s_lshl_b32 s79, s79, 11
    s_mov_b32 s83, 0
    v_lshlrev_b32 v65, 2, v0
    v_mov_b32 v44, -1
    s_waitcnt lgkmcnt(0)
    s_mov_b32 s48, s24
    s_mov_b32 s49, s25
    s_lshl3_add_u32 s6, s2, s3
    s_mov_b32 s4, 1048576
    s_lshl3_add_u32 s80, s80, s4
    v_and_b32 v1, 63, v0
    s_cmp_lg_u32 s6, 1
    s_cbranch_scc1 L_nopoison
    v_mov_b32 v45, -1
    v_mov_b32 v46, -1
    v_mov_b32 v47, -1
    v_lshlrev_b32 v48, 4, v1
    buffer_store_dwordx4 v[44:47], v48, s[48:51], s4 offen sc1
    buffer_store_dwordx4 v[44:47], v48, s[48:51], s4 offen offset:1024 sc1
L_nopoison:
    s_waitcnt vmcnt(7)
    v_lshlrev_b32 v61, 5, v3
    v_lshl_add_u32 v61, v7, 7, v61
    s_lshl_b32 s27, s63, 10
    s_add_u32 s44, s8, s27
    s_addc_u32 s45, s9, 0
    s_movk_i32 s46, 0x400
    s_mov_b32 s47, s31
    s_lshr_b32 s4, s74, 9
    buffer_load_dwordx2 v[20:21], v61, s[44:47], s4 offen
    s_lshr_b32 s4, s75, 9
    buffer_load_dwordx2 v[22:23], v61, s[44:47], s4 offen
    s_lshr_b32 s4, s76, 9
    buffer_load_dwordx2 v[24:25], v61, s[44:47], s4 offen
    s_lshr_b32 s4, s77, 9
    buffer_load_dwordx2 v[26:27], v61, s[44:47], s4 offen
    s_waitcnt vmcnt(10)
    s_add_u32 s32, s12, s18
    s_addc_u32 s33, s13, 0
    s_mov_b32 s34, s30
    s_mov_b32 s35, s31
    s_lshl_b32 s26, s62, 17
    s_add_u32 s40, s16, s26
    s_addc_u32 s41, s17, 0
    s_mov_b32 s42, s31
    s_mov_b32 s43, s31
    s_mov_b32 s52, s20
    s_mov_b32 s53, s21
    s_movk_i32 s54, 0x1000
    s_mov_b32 s55, s31
    s_mov_b32 s56, s22
    s_mov_b32 s57, s23
    s_movk_i32 s58, 0x100
    s_mov_b32 s59, s31
    s_waitcnt vmcnt(9)
    v_and_b32 v60, 1, v2
    v_lshlrev_b32 v60, 4, v60
    v_mov_b32 v62, 0xffff
    v_lshlrev_b32 v62, v60, v62
    v_bfe_u32 v60, v0, 1, 2
    v_cmp_eq_u32 vcc, 0, v60
    s_nop 1
    v_cndmask_b32 v8, 0, v62, vcc
    v_cmp_eq_u32 vcc, 1, v60
    s_nop 1
    v_cndmask_b32 v9, 0, v62, vcc
    v_cmp_eq_u32 vcc, 2, v60
    s_nop 1
    v_cndmask_b32 v10, 0, v62, vcc
    v_cmp_eq_u32 vcc, 3, v60
    s_nop 1
    v_cndmask_b32 v11, 0, v62, vcc
    s_waitcnt vmcnt(8)
    s_mov_b32 s4, 0x0c0c0c0c
    v_mov_b32 v60, 0x01000100
    v_mov_b32 v62, 0x03020302
    v_bfi_b32 v12, v8, v60, s4
    v_bfi_b32 v16, v8, v62, s4
    v_bfi_b32 v13, v9, v60, s4
    v_bfi_b32 v17, v9, v62, s4
    v_bfi_b32 v14, v10, v60, s4
    v_bfi_b32 v18, v10, v62, s4
    v_bfi_b32 v15, v11, v60, s4
    v_bfi_b32 v19, v11, v62, s4
    s_waitcnt vmcnt(7)
    v_lshlrev_b32 v60, 1, v3
    v_and_b32 v6, 7, v0
    v_xor_b32 v6, v6, v60
    v_lshlrev_b32 v6, 4, v6
    v_bfe_u32 v60, v0, 3, 3
    v_lshl_add_u32 v6, v60, 10, v6
    v_lshl_add_u32 v6, v7, 7, v6
    s_lshl_b32 s19, s3, 14
    s_add_u32 s19, s19, 8192
    s_waitcnt vmcnt(6)
    v_lshlrev_b32 v60, 5, v2
    v_lshl_add_u32 v60, v3, 4, v60
    s_mul_i32 s5, s3, 528
    v_add_u32 v60, s5, v60
    v_and_b32 v61, 3, v0
    v_mul_u32_u24 v61, 1056, v61
    v_lshrrev_b32 v62, 2, v0
    v_lshl_add_u32 v61, v62, 2, v61
    v_lshlrev_b32 v62, 1, v62
    s_waitcnt vmcnt(5)
    s_waitcnt vmcnt(4)
    s_lshl_b32 s81, s75, 3
    buffer_load_dwordx4 v[100:103], v5, s[36:39], s81 offen
    buffer_load_dwordx4 v[104:107], v4, s[28:31], s67 offen offset:0 nt
    buffer_load_dwordx4 v[108:111], v4, s[28:31], s67 offen offset:1024 nt
    s_add_u32 s81, s81, 0x2000
    buffer_load_dwordx4 v[112:115], v5, s[36:39], s81 offen
    buffer_load_dwordx4 v[116:119], v4, s[28:31], s67 offen offset:2048 nt
    buffer_load_dwordx4 v[120:123], v4, s[28:31], s67 offen offset:3072 nt
    s_add_u32 s81, s81, 0x2000
    buffer_load_dwordx4 v[124:127], v5, s[36:39], s81 offen
    buffer_load_dwordx4 v[128:131], v4, s[28:31], s68 offen offset:0 nt
    buffer_load_dwordx4 v[132:135], v4, s[28:31], s68 offen offset:1024 nt
    s_add_u32 s81, s81, 0x2000
    buffer_load_dwordx4 v[136:139], v5, s[36:39], s81 offen
    s_waitcnt vmcnt(10)
    v_perm_b32 v32, v20, v20, v12
    v_perm_b32 v33, v20, v20, v13
    v_perm_b32 v34, v20, v20, v14
    v_perm_b32 v35, v20, v20, v15
    s_nop 1
    v_mfma_f32_16x16x32_bf16 v[40:43], v[32:35], v[84:87], 0
    v_perm_b32 v36, v20, v20, v16
    v_perm_b32 v37, v20, v20, v17
    v_perm_b32 v38, v20, v20, v18
    v_perm_b32 v39, v20, v20, v19
    s_nop 1
    v_mfma_f32_16x16x32_bf16 v[40:43], v[36:39], v[88:91], v[40:43]
    v_perm_b32 v32, v21, v21, v12
    v_perm_b32 v33, v21, v21, v13
    v_perm_b32 v34, v21, v21, v14
    v_perm_b32 v35, v21, v21, v15
    s_nop 1
    v_mfma_f32_16x16x32_bf16 v[40:43], v[32:35], v[92:95], v[40:43]
    v_perm_b32 v36, v21, v21, v16
    v_perm_b32 v37, v21, v21, v17
    v_perm_b32 v38, v21, v21, v18
    v_perm_b32 v39, v21, v21, v19
    s_nop 1
    v_mfma_f32_16x16x32_bf16 v[40:43], v[36:39], v[96:99], v[40:43]
    v_perm_b32 v32, v22, v22, v12
    v_perm_b32 v33, v22, v22, v13
    v_perm_b32 v34, v22, v22, v14
    v_perm_b32 v35, v22, v22, v15
    s_waitcnt vmcnt(9)
    s_cmp_lg_u32 s6, 1
    s_cbranch_scc1 L_nosignal
    v_mov_b32 v48, 1
    v_mov_b32 v49, 0
    s_mov_b64 exec, 1
    buffer_store_dword v48, v49, s[56:59], 0 offen sc1
    s_mov_b64 exec, -1
L_nosignal:
    s_nop 1
    v_mfma_f32_16x16x32_bf16 v[40:43], v[32:35], v[100:103], v[40:43]
    v_perm_b32 v36, v22, v22, v16
    v_perm_b32 v37, v22, v22, v17
    v_perm_b32 v38, v22, v22, v18
    v_perm_b32 v39, v22, v22, v19
    s_waitcnt vmcnt(8)
    buffer_load_dwordx4 v[140:143], v4, s[28:31], s68 offen offset:2048 nt
    s_waitcnt vmcnt(8)
    buffer_load_dwordx4 v[144:147], v4, s[28:31], s68 offen offset:3072 nt
    s_lshl_b32 s81, s76, 3
    buffer_load_dwordx4 v[148:151], v5, s[36:39], s81 offen
    s_waitcnt vmcnt(9)
    v_mfma_f32_16x16x32_bf16 v[40:43], v[36:39], v[112:115], v[40:43]
    v_perm_b32 v32, v23, v23, v12
    v_perm_b32 v33, v23, v23, v13
    v_perm_b32 v34, v23, v23, v14
    v_perm_b32 v35, v23, v23, v15
    s_waitcnt vmcnt(8)
    buffer_load_dwordx4 v[152:155], v4, s[28:31], s69 offen offset:0 nt
    s_waitcnt vmcnt(8)
    buffer_load_dwordx4 v[156:159], v4, s[28:31], s69 offen offset:1024 nt
    s_add_u32 s81, s81, 0x2000
    buffer_load_dwordx4 v[160:163], v5, s[36:39], s81 offen
    s_waitcnt vmcnt(9)
    v_mfma_f32_16x16x32_bf16 v[40:43], v[32:35], v[124:127], v[40:43]
    v_perm_b32 v36, v23, v23, v16
    v_perm_b32 v37, v23, v23, v17
    v_perm_b32 v38, v23, v23, v18
    v_perm_b32 v39, v23, v23, v19
    s_waitcnt vmcnt(8)
    buffer_load_dwordx4 v[164:167], v4, s[28:31], s69 offen offset:2048 nt
    s_waitcnt vmcnt(8)
    buffer_load_dwordx4 v[168:171], v4, s[28:31], s69 offen offset:3072 nt
    s_add_u32 s81, s81, 0x2000
    buffer_load_dwordx4 v[172:175], v5, s[36:39], s81 offen
    s_waitcnt vmcnt(9)
    v_mfma_f32_16x16x32_bf16 v[40:43], v[36:39], v[136:139], v[40:43]
    v_perm_b32 v32, v24, v24, v12
    v_perm_b32 v33, v24, v24, v13
    v_perm_b32 v34, v24, v24, v14
    v_perm_b32 v35, v24, v24, v15
    s_waitcnt vmcnt(8)
    buffer_load_dwordx4 v[176:179], v4, s[28:31], s70 offen offset:0 nt
    s_waitcnt vmcnt(8)
    buffer_load_dwordx4 v[180:183], v4, s[28:31], s70 offen offset:1024 nt
    s_add_u32 s81, s81, 0x2000
    buffer_load_dwordx4 v[184:187], v5, s[36:39], s81 offen
    s_waitcnt vmcnt(9)
    v_mfma_f32_16x16x32_bf16 v[40:43], v[32:35], v[148:151], v[40:43]
    s_cmp_ge_u32 s3, 4
    s_cbranch_scc1 L_noyp
    v_mov_b32 v44, -1
    v_mov_b32 v45, -1
    v_mov_b32 v46, -1
    v_mov_b32 v47, -1
    v_lshlrev_b32 v48, 3, v0
    buffer_store_dwordx2 v[44:45], v48, s[48:51], s79 offen sc1
L_noyp:
    v_perm_b32 v36, v24, v24, v16
    v_perm_b32 v37, v24, v24, v17
    v_perm_b32 v38, v24, v24, v18
    v_perm_b32 v39, v24, v24, v19
    s_waitcnt vmcnt(8)
    buffer_load_dwordx4 v[188:191], v4, s[28:31], s70 offen offset:2048 nt
    s_waitcnt vmcnt(8)
    buffer_load_dwordx4 v[192:195], v4, s[28:31], s70 offen offset:3072 nt
    s_lshl_b32 s81, s77, 3
    buffer_load_dwordx4 v[196:199], v5, s[36:39], s81 offen
    s_waitcnt vmcnt(9)
    v_mfma_f32_16x16x32_bf16 v[40:43], v[36:39], v[160:163], v[40:43]
    v_perm_b32 v32, v25, v25, v12
    v_perm_b32 v33, v25, v25, v13
    v_perm_b32 v34, v25, v25, v14
    v_perm_b32 v35, v25, v25, v15
    s_waitcnt vmcnt(8)
    buffer_load_dwordx4 v[200:203], v4, s[28:31], s71 offen offset:0 nt
    s_waitcnt vmcnt(8)
    buffer_load_dwordx4 v[204:207], v4, s[28:31], s71 offen offset:1024 nt
    s_add_u32 s81, s81, 0x2000
    buffer_load_dwordx4 v[208:211], v5, s[36:39], s81 offen
    s_waitcnt vmcnt(9)
    v_mfma_f32_16x16x32_bf16 v[40:43], v[32:35], v[172:175], v[40:43]
    v_perm_b32 v36, v25, v25, v16
    v_perm_b32 v37, v25, v25, v17
    v_perm_b32 v38, v25, v25, v18
    v_perm_b32 v39, v25, v25, v19
    s_waitcnt vmcnt(8)
    buffer_load_dwordx4 v[212:215], v4, s[28:31], s71 offen offset:2048 nt
    s_waitcnt vmcnt(8)
    buffer_load_dwordx4 v[216:219], v4, s[28:31], s71 offen offset:3072 nt
    s_add_u32 s81, s81, 0x2000
    buffer_load_dwordx4 v[220:223], v5, s[36:39], s81 offen
    s_waitcnt vmcnt(9)
    v_mfma_f32_16x16x32_bf16 v[40:43], v[36:39], v[184:187], v[40:43]
    v_perm_b32 v32, v26, v26, v12
    v_perm_b32 v33, v26, v26, v13
    v_perm_b32 v34, v26, v26, v14
    v_perm_b32 v35, v26, v26, v15
    s_waitcnt vmcnt(8)
    buffer_load_dwordx4 v[224:227], v4, s[28:31], s72 offen offset:0 nt
    s_waitcnt vmcnt(8)
    buffer_load_dwordx4 v[228:231], v4, s[28:31], s72 offen offset:1024 nt
    s_add_u32 s81, s81, 0x2000
    buffer_load_dwordx4 v[232:235], v5, s[36:39], s81 offen
    s_waitcnt vmcnt(9)
    v_mfma_f32_16x16x32_bf16 v[40:43], v[32:35], v[196:199], v[40:43]
    s_cmp_lg_u32 s3, 0
    s_cbranch_scc1 L_noflag
    v_mov_b32 v64, 0
    buffer_load_dword v64, v64, s[56:59], 0 offen sc1
L_noflag:
    v_perm_b32 v36, v26, v26, v16
    v_perm_b32 v37, v26, v26, v17
    v_perm_b32 v38, v26, v26, v18
    v_perm_b32 v39, v26, v26, v19
    s_waitcnt vmcnt(8)
    buffer_load_dwordx4 v[236:239], v4, s[28:31], s72 offen offset:2048 nt
    s_waitcnt vmcnt(8)
    buffer_load_dwordx4 v[240:243], v4, s[28:31], s72 offen offset:3072 nt
    s_waitcnt vmcnt(8)
    v_mfma_f32_16x16x32_bf16 v[40:43], v[36:39], v[208:211], v[40:43]
    v_perm_b32 v32, v27, v27, v12
    v_perm_b32 v33, v27, v27, v13
    v_perm_b32 v34, v27, v27, v14
    v_perm_b32 v35, v27, v27, v15
    s_waitcnt vmcnt(7)
    buffer_load_dwordx4 v[244:247], v4, s[28:31], s73 offen offset:0 nt
    s_waitcnt vmcnt(7)
    buffer_load_dwordx4 v[248:251], v4, s[28:31], s73 offen offset:1024 nt
    s_waitcnt vmcnt(7)
    v_mfma_f32_16x16x32_bf16 v[40:43], v[32:35], v[220:223], v[40:43]
    v_perm_b32 v36, v27, v27, v16
    v_perm_b32 v37, v27, v27, v17
    v_perm_b32 v38, v27, v27, v18
    v_perm_b32 v39, v27, v27, v19
    s_waitcnt vmcnt(6)
    buffer_load_dwordx4 v[84:87], v4, s[28:31], s73 offen offset:2048 nt
    s_waitcnt vmcnt(6)
    buffer_load_dwordx4 v[88:91], v4, s[28:31], s73 offen offset:3072 nt
    s_waitcnt vmcnt(6)
    v_mfma_f32_16x16x32_bf16 v[40:43], v[36:39], v[232:235], v[40:43]
    buffer_load_dwordx4 v[92:95], v4, s[32:35], s66 offen offset:0 nt
    buffer_load_dwordx4 v[96:99], v4, s[32:35], s66 offen offset:1024 nt
    buffer_load_dwordx4 v[100:103], v4, s[32:35], s66 offen offset:2048 nt
    s_mov_b32 exec_hi, 0
    s_nop 3
    ds_write_b128 v60, v[40:43] offset:0
    s_mov_b32 exec_hi, -1
    v_lshlrev_b32 v44, 4, v2
    s_waitcnt lgkmcnt(0)
    s_barrier
    ds_read2_b32 v[46:47], v61 offset0:0 offset1:132
    s_waitcnt lgkmcnt(0)
    v_add_f32 v46, v46, v47
    s_nop 1
    v_add_f32_dpp v46, v46, v46 quad_perm:[1,0,3,2] row_mask:0xf bank_mask:0xf
    s_nop 1
    v_add_f32_dpp v46, v46, v46 quad_perm:[2,3,0,1] row_mask:0xf bank_mask:0xf
    v_cvt_pk_bf16_f32 v46, v46, v46
    ds_write_b16 v62, v46 offset:4352
    s_waitcnt lgkmcnt(0)
    s_barrier
    ds_read_b128 v[28:31], v44 offset:4352
    s_waitcnt vmcnt(8)
    s_waitcnt vmcnt(7)
    s_waitcnt vmcnt(6)
    s_waitcnt vmcnt(5)
    s_waitcnt vmcnt(4)
    buffer_load_dwordx4 v[112:115], v4, s[32:35], s66 offen offset:3072 nt
    s_waitcnt lgkmcnt(0)
    v_dot2_f32_bf16 v44, v68, v28, 0
    v_dot2_f32_bf16 v45, v72, v28, 0
    v_dot2_f32_bf16 v46, v76, v28, 0
    v_dot2_f32_bf16 v47, v80, v28, 0
    v_dot2_f32_bf16 v44, v69, v29, v44
    v_dot2_f32_bf16 v45, v73, v29, v45
    v_dot2_f32_bf16 v46, v77, v29, v46
    v_dot2_f32_bf16 v47, v81, v29, v47
    v_dot2_f32_bf16 v44, v70, v30, v44
    v_dot2_f32_bf16 v45, v74, v30, v45
    v_dot2_f32_bf16 v46, v78, v30, v46
    v_dot2_f32_bf16 v47, v82, v30, v47
    v_dot2_f32_bf16 v44, v71, v31, v44
    v_dot2_f32_bf16 v45, v75, v31, v45
    v_dot2_f32_bf16 v46, v79, v31, v46
    v_dot2_f32_bf16 v47, v83, v31, v47
    v_add_f32_dpp v44, v44, v44 row_ror:8 row_mask:0xf bank_mask:0x3
    s_nop 0
    v_add_f32_dpp v46, v46, v46 row_ror:8 row_mask:0xf bank_mask:0x3
    v_add_f32_dpp v44, v45, v45 row_ror:8 row_mask:0xf bank_mask:0xc
    s_nop 0
    v_add_f32_dpp v46, v47, v47 row_ror:8 row_mask:0xf bank_mask:0xc
    v_add_f32_dpp v52, v44, v44 row_half_mirror row_mask:0xf bank_mask:0x5
    s_nop 1
    v_add_f32_dpp v52, v46, v46 row_half_mirror row_mask:0xf bank_mask:0xa
    s_nop 1
    v_add_f32_dpp v52, v52, v52 quad_perm:[1,0,3,2] row_mask:0xf bank_mask:0xf
    s_nop 1
    v_add_f32_dpp v52, v52, v52 quad_perm:[2,3,0,1] row_mask:0xf bank_mask:0xf
    v_dot2_f32_bf16 v48, v104, v28, 0
    v_dot2_f32_bf16 v49, v108, v28, 0
    v_dot2_f32_bf16 v50, v116, v28, 0
    v_dot2_f32_bf16 v51, v120, v28, 0
    v_dot2_f32_bf16 v48, v105, v29, v48
    v_dot2_f32_bf16 v49, v109, v29, v49
    v_dot2_f32_bf16 v50, v117, v29, v50
    v_dot2_f32_bf16 v51, v121, v29, v51
    v_dot2_f32_bf16 v48, v106, v30, v48
    v_dot2_f32_bf16 v49, v110, v30, v49
    v_dot2_f32_bf16 v50, v118, v30, v50
    v_dot2_f32_bf16 v51, v122, v30, v51
    v_dot2_f32_bf16 v48, v107, v31, v48
    v_dot2_f32_bf16 v49, v111, v31, v49
    v_dot2_f32_bf16 v50, v119, v31, v50
    v_dot2_f32_bf16 v51, v123, v31, v51
    v_add_f32_dpp v48, v48, v48 row_ror:8 row_mask:0xf bank_mask:0x3
    s_nop 0
    v_add_f32_dpp v50, v50, v50 row_ror:8 row_mask:0xf bank_mask:0x3
    v_add_f32_dpp v48, v49, v49 row_ror:8 row_mask:0xf bank_mask:0xc
    s_nop 0
    v_add_f32_dpp v50, v51, v51 row_ror:8 row_mask:0xf bank_mask:0xc
    v_add_f32_dpp v53, v48, v48 row_half_mirror row_mask:0xf bank_mask:0x5
    s_nop 1
    v_add_f32_dpp v53, v50, v50 row_half_mirror row_mask:0xf bank_mask:0xa
    s_nop 1
    v_add_f32_dpp v53, v53, v53 quad_perm:[1,0,3,2] row_mask:0xf bank_mask:0xf
    s_nop 1
    v_add_f32_dpp v53, v53, v53 quad_perm:[2,3,0,1] row_mask:0xf bank_mask:0xf
    v_dot2_f32_bf16 v44, v128, v28, 0
    v_dot2_f32_bf16 v45, v132, v28, 0
    v_dot2_f32_bf16 v46, v140, v28, 0
    v_dot2_f32_bf16 v47, v144, v28, 0
    v_dot2_f32_bf16 v44, v129, v29, v44
    v_dot2_f32_bf16 v45, v133, v29, v45
    v_dot2_f32_bf16 v46, v141, v29, v46
    v_dot2_f32_bf16 v47, v145, v29, v47
    v_dot2_f32_bf16 v44, v130, v30, v44
    v_dot2_f32_bf16 v45, v134, v30, v45
    v_dot2_f32_bf16 v46, v142, v30, v46
    v_dot2_f32_bf16 v47, v146, v30, v47
    v_dot2_f32_bf16 v44, v131, v31, v44
    v_dot2_f32_bf16 v45, v135, v31, v45
    v_dot2_f32_bf16 v46, v143, v31, v46
    v_dot2_f32_bf16 v47, v147, v31, v47
    v_add_f32_dpp v44, v44, v44 row_ror:8 row_mask:0xf bank_mask:0x3
    s_nop 0
    v_add_f32_dpp v46, v46, v46 row_ror:8 row_mask:0xf bank_mask:0x3
    v_add_f32_dpp v44, v45, v45 row_ror:8 row_mask:0xf bank_mask:0xc
    s_nop 0
    v_add_f32_dpp v46, v47, v47 row_ror:8 row_mask:0xf bank_mask:0xc
    v_add_f32_dpp v54, v44, v44 row_half_mirror row_mask:0xf bank_mask:0x5
    s_nop 1
    v_add_f32_dpp v54, v46, v46 row_half_mirror row_mask:0xf bank_mask:0xa
    s_nop 1
    v_add_f32_dpp v54, v54, v54 quad_perm:[1,0,3,2] row_mask:0xf bank_mask:0xf
    s_nop 1
    v_add_f32_dpp v54, v54, v54 quad_perm:[2,3,0,1] row_mask:0xf bank_mask:0xf
    v_dot2_f32_bf16 v48, v152, v28, 0
    v_dot2_f32_bf16 v49, v156, v28, 0
    v_dot2_f32_bf16 v50, v164, v28, 0
    v_dot2_f32_bf16 v51, v168, v28, 0
    v_dot2_f32_bf16 v48, v153, v29, v48
    v_dot2_f32_bf16 v49, v157, v29, v49
    v_dot2_f32_bf16 v50, v165, v29, v50
    v_dot2_f32_bf16 v51, v169, v29, v51
    v_dot2_f32_bf16 v48, v154, v30, v48
    v_dot2_f32_bf16 v49, v158, v30, v49
    v_dot2_f32_bf16 v50, v166, v30, v50
    v_dot2_f32_bf16 v51, v170, v30, v51
    v_dot2_f32_bf16 v48, v155, v31, v48
    v_dot2_f32_bf16 v49, v159, v31, v49
    v_dot2_f32_bf16 v50, v167, v31, v50
    v_dot2_f32_bf16 v51, v171, v31, v51
    v_add_f32_dpp v48, v48, v48 row_ror:8 row_mask:0xf bank_mask:0x3
    s_nop 0
    v_add_f32_dpp v50, v50, v50 row_ror:8 row_mask:0xf bank_mask:0x3
    v_add_f32_dpp v48, v49, v49 row_ror:8 row_mask:0xf bank_mask:0xc
    s_nop 0
    v_add_f32_dpp v50, v51, v51 row_ror:8 row_mask:0xf bank_mask:0xc
    v_add_f32_dpp v55, v48, v48 row_half_mirror row_mask:0xf bank_mask:0x5
    s_nop 1
    v_add_f32_dpp v55, v50, v50 row_half_mirror row_mask:0xf bank_mask:0xa
    s_nop 1
    v_add_f32_dpp v55, v55, v55 quad_perm:[1,0,3,2] row_mask:0xf bank_mask:0xf
    s_nop 1
    v_add_f32_dpp v55, v55, v55 quad_perm:[2,3,0,1] row_mask:0xf bank_mask:0xf
    v_dot2_f32_bf16 v44, v176, v28, 0
    v_dot2_f32_bf16 v45, v180, v28, 0
    v_dot2_f32_bf16 v46, v188, v28, 0
    v_dot2_f32_bf16 v47, v192, v28, 0
    v_dot2_f32_bf16 v44, v177, v29, v44
    v_dot2_f32_bf16 v45, v181, v29, v45
    v_dot2_f32_bf16 v46, v189, v29, v46
    v_dot2_f32_bf16 v47, v193, v29, v47
    v_dot2_f32_bf16 v44, v178, v30, v44
    v_dot2_f32_bf16 v45, v182, v30, v45
    v_dot2_f32_bf16 v46, v190, v30, v46
    v_dot2_f32_bf16 v47, v194, v30, v47
    v_dot2_f32_bf16 v44, v179, v31, v44
    v_dot2_f32_bf16 v45, v183, v31, v45
    v_dot2_f32_bf16 v46, v191, v31, v46
    v_dot2_f32_bf16 v47, v195, v31, v47
    v_add_f32_dpp v44, v44, v44 row_ror:8 row_mask:0xf bank_mask:0x3
    s_nop 0
    v_add_f32_dpp v46, v46, v46 row_ror:8 row_mask:0xf bank_mask:0x3
    v_add_f32_dpp v44, v45, v45 row_ror:8 row_mask:0xf bank_mask:0xc
    s_nop 0
    v_add_f32_dpp v46, v47, v47 row_ror:8 row_mask:0xf bank_mask:0xc
    v_add_f32_dpp v56, v44, v44 row_half_mirror row_mask:0xf bank_mask:0x5
    s_nop 1
    v_add_f32_dpp v56, v46, v46 row_half_mirror row_mask:0xf bank_mask:0xa
    s_nop 1
    v_add_f32_dpp v56, v56, v56 quad_perm:[1,0,3,2] row_mask:0xf bank_mask:0xf
    s_nop 1
    v_add_f32_dpp v56, v56, v56 quad_perm:[2,3,0,1] row_mask:0xf bank_mask:0xf
    v_dot2_f32_bf16 v48, v200, v28, 0
    v_dot2_f32_bf16 v49, v204, v28, 0
    v_dot2_f32_bf16 v50, v212, v28, 0
    v_dot2_f32_bf16 v51, v216, v28, 0
    v_dot2_f32_bf16 v48, v201, v29, v48
    v_dot2_f32_bf16 v49, v205, v29, v49
    v_dot2_f32_bf16 v50, v213, v29, v50
    v_dot2_f32_bf16 v51, v217, v29, v51
    v_dot2_f32_bf16 v48, v202, v30, v48
    v_dot2_f32_bf16 v49, v206, v30, v49
    v_dot2_f32_bf16 v50, v214, v30, v50
    v_dot2_f32_bf16 v51, v218, v30, v51
    v_dot2_f32_bf16 v48, v203, v31, v48
    v_dot2_f32_bf16 v49, v207, v31, v49
    v_dot2_f32_bf16 v50, v215, v31, v50
    v_dot2_f32_bf16 v51, v219, v31, v51
    v_add_f32_dpp v48, v48, v48 row_ror:8 row_mask:0xf bank_mask:0x3
    s_nop 0
    v_add_f32_dpp v50, v50, v50 row_ror:8 row_mask:0xf bank_mask:0x3
    v_add_f32_dpp v48, v49, v49 row_ror:8 row_mask:0xf bank_mask:0xc
    s_nop 0
    v_add_f32_dpp v50, v51, v51 row_ror:8 row_mask:0xf bank_mask:0xc
    v_add_f32_dpp v57, v48, v48 row_half_mirror row_mask:0xf bank_mask:0x5
    s_nop 1
    v_add_f32_dpp v57, v50, v50 row_half_mirror row_mask:0xf bank_mask:0xa
    s_nop 1
    v_add_f32_dpp v57, v57, v57 quad_perm:[1,0,3,2] row_mask:0xf bank_mask:0xf
    s_nop 1
    v_add_f32_dpp v57, v57, v57 quad_perm:[2,3,0,1] row_mask:0xf bank_mask:0xf
    v_dot2_f32_bf16 v44, v224, v28, 0
    v_dot2_f32_bf16 v45, v228, v28, 0
    v_dot2_f32_bf16 v46, v236, v28, 0
    v_dot2_f32_bf16 v47, v240, v28, 0
    v_dot2_f32_bf16 v44, v225, v29, v44
    v_dot2_f32_bf16 v45, v229, v29, v45
    v_dot2_f32_bf16 v46, v237, v29, v46
    v_dot2_f32_bf16 v47, v241, v29, v47
    v_dot2_f32_bf16 v44, v226, v30, v44
    v_dot2_f32_bf16 v45, v230, v30, v45
    v_dot2_f32_bf16 v46, v238, v30, v46
    v_dot2_f32_bf16 v47, v242, v30, v47
    v_dot2_f32_bf16 v44, v227, v31, v44
    v_dot2_f32_bf16 v45, v231, v31, v45
    v_dot2_f32_bf16 v46, v239, v31, v46
    v_dot2_f32_bf16 v47, v243, v31, v47
    v_add_f32_dpp v44, v44, v44 row_ror:8 row_mask:0xf bank_mask:0x3
    s_nop 0
    v_add_f32_dpp v46, v46, v46 row_ror:8 row_mask:0xf bank_mask:0x3
    v_add_f32_dpp v44, v45, v45 row_ror:8 row_mask:0xf bank_mask:0xc
    s_nop 0
    v_add_f32_dpp v46, v47, v47 row_ror:8 row_mask:0xf bank_mask:0xc
    v_add_f32_dpp v58, v44, v44 row_half_mirror row_mask:0xf bank_mask:0x5
    s_nop 1
    v_add_f32_dpp v58, v46, v46 row_half_mirror row_mask:0xf bank_mask:0xa
    s_nop 1
    v_add_f32_dpp v58, v58, v58 quad_perm:[1,0,3,2] row_mask:0xf bank_mask:0xf
    s_nop 1
    v_add_f32_dpp v58, v58, v58 quad_perm:[2,3,0,1] row_mask:0xf bank_mask:0xf
    s_waitcnt vmcnt(4)
    buffer_load_dwordx4 v[124:127], v4, s[32:35], s67 offen offset:0 nt
    v_dot2_f32_bf16 v48, v244, v28, 0
    v_dot2_f32_bf16 v49, v248, v28, 0
    v_dot2_f32_bf16 v50, v84, v28, 0
    v_dot2_f32_bf16 v51, v88, v28, 0
    v_dot2_f32_bf16 v48, v245, v29, v48
    v_dot2_f32_bf16 v49, v249, v29, v49
    v_dot2_f32_bf16 v50, v85, v29, v50
    v_dot2_f32_bf16 v51, v89, v29, v51
    v_dot2_f32_bf16 v48, v246, v30, v48
    v_dot2_f32_bf16 v49, v250, v30, v49
    v_dot2_f32_bf16 v50, v86, v30, v50
    v_dot2_f32_bf16 v51, v90, v30, v51
    v_dot2_f32_bf16 v48, v247, v31, v48
    v_dot2_f32_bf16 v49, v251, v31, v49
    v_dot2_f32_bf16 v50, v87, v31, v50
    v_dot2_f32_bf16 v51, v91, v31, v51
    v_add_f32_dpp v48, v48, v48 row_ror:8 row_mask:0xf bank_mask:0x3
    s_nop 0
    v_add_f32_dpp v50, v50, v50 row_ror:8 row_mask:0xf bank_mask:0x3
    v_add_f32_dpp v48, v49, v49 row_ror:8 row_mask:0xf bank_mask:0xc
    s_nop 0
    v_add_f32_dpp v50, v51, v51 row_ror:8 row_mask:0xf bank_mask:0xc
    v_add_f32_dpp v59, v48, v48 row_half_mirror row_mask:0xf bank_mask:0x5
    s_nop 1
    v_add_f32_dpp v59, v50, v50 row_half_mirror row_mask:0xf bank_mask:0xa
    s_nop 1
    v_add_f32_dpp v59, v59, v59 quad_perm:[1,0,3,2] row_mask:0xf bank_mask:0xf
    s_nop 1
    v_add_f32_dpp v59, v59, v59 quad_perm:[2,3,0,1] row_mask:0xf bank_mask:0xf
    buffer_load_dwordx4 v[136:139], v4, s[32:35], s67 offen offset:1024 nt
    buffer_load_dwordx4 v[148:151], v4, s[32:35], s67 offen offset:2048 nt
    s_mov_b32 s4, 0xffff0000
    s_mov_b32 s5, 0x3db504f3
    s_mov_b32 s6, 0x3fb8aa3b
    v_cvt_pk_bf16_f32 v52, v52, v52
    v_cvt_pk_bf16_f32 v53, v53, v53
    v_cvt_pk_bf16_f32 v54, v54, v54
    v_cvt_pk_bf16_f32 v55, v55, v55
    v_cvt_pk_bf16_f32 v56, v56, v56
    v_cvt_pk_bf16_f32 v57, v57, v57
    v_cvt_pk_bf16_f32 v58, v58, v58
    v_cvt_pk_bf16_f32 v59, v59, v59
    v_and_b32 v52, s4, v52
    v_and_b32 v53, s4, v53
    v_and_b32 v54, s4, v54
    v_and_b32 v55, s4, v55
    v_and_b32 v56, s4, v56
    v_and_b32 v57, s4, v57
    v_and_b32 v58, s4, v58
    v_and_b32 v59, s4, v59
    v_mul_f32 v52, s5, v52
    v_mul_f32 v53, s5, v53
    v_mul_f32 v54, s5, v54
    v_mul_f32 v55, s5, v55
    v_mul_f32 v56, s5, v56
    v_mul_f32 v57, s5, v57
    v_mul_f32 v58, s5, v58
    v_mul_f32 v59, s5, v59
    v_cvt_pk_bf16_f32 v52, v52, v52
    v_cvt_pk_bf16_f32 v53, v53, v53
    v_cvt_pk_bf16_f32 v54, v54, v54
    v_cvt_pk_bf16_f32 v55, v55, v55
    v_cvt_pk_bf16_f32 v56, v56, v56
    v_cvt_pk_bf16_f32 v57, v57, v57
    v_cvt_pk_bf16_f32 v58, v58, v58
    v_cvt_pk_bf16_f32 v59, v59, v59
    v_and_b32 v52, s4, v52
    v_and_b32 v53, s4, v53
    v_and_b32 v54, s4, v54
    v_and_b32 v55, s4, v55
    v_and_b32 v56, s4, v56
    v_and_b32 v57, s4, v57
    v_and_b32 v58, s4, v58
    v_and_b32 v59, s4, v59
    v_max3_f32 v44, v52, v53, v54
    v_max3_f32 v45, v55, v56, v57
    v_max3_f32 v44, v44, v58, v59
    v_max_f32 v44, v44, v45
    s_nop 1
    v_max_f32_dpp v44, v44, v44 row_ror:4 row_mask:0xf bank_mask:0xf
    s_nop 1
    v_max_f32_dpp v44, v44, v44 row_ror:8 row_mask:0xf bank_mask:0xf
    v_mov_b32 v45, v44
    s_nop 1
    v_permlane16_swap_b32 v44, v45
    v_max_f32 v44, v44, v45
    v_mov_b32 v45, v44
    s_nop 1
    v_permlane32_swap_b32 v44, v45
    v_max_f32 v44, v44, v45
    v_sub_f32 v52, v52, v44
    v_sub_f32 v53, v53, v44
    v_sub_f32 v54, v54, v44
    v_sub_f32 v55, v55, v44
    v_sub_f32 v56, v56, v44
    v_sub_f32 v57, v57, v44
    v_sub_f32 v58, v58, v44
    v_sub_f32 v59, v59, v44
    v_mul_f32 v52, s6, v52
    v_mul_f32 v53, s6, v53
    v_mul_f32 v54, s6, v54
    v_mul_f32 v55, s6, v55
    v_mul_f32 v56, s6, v56
    v_mul_f32 v57, s6, v57
    v_mul_f32 v58, s6, v58
    v_mul_f32 v59, s6, v59
    v_exp_f32 v52, v52
    v_exp_f32 v53, v53
    v_exp_f32 v54, v54
    v_exp_f32 v55, v55
    v_exp_f32 v56, v56
    v_exp_f32 v57, v57
    v_exp_f32 v58, v58
    v_exp_f32 v59, v59
    v_add_f32 v45, v52, v53
    v_add_f32 v46, v54, v55
    v_add_f32 v47, v56, v57
    v_add_f32 v48, v58, v59
    v_add_f32 v45, v45, v46
    v_add_f32 v47, v47, v48
    v_add_f32 v45, v45, v47
    s_nop 1
    v_add_f32_dpp v45, v45, v45 row_ror:4 row_mask:0xf bank_mask:0xf
    s_nop 1
    v_add_f32_dpp v45, v45, v45 row_ror:8 row_mask:0xf bank_mask:0xf
    v_mov_b32 v46, v45
    s_nop 1
    v_permlane16_swap_b32 v45, v46
    v_add_f32 v45, v45, v46
    v_mov_b32 v46, v45
    s_nop 1
    v_permlane32_swap_b32 v45, v46
    v_add_f32 v45, v45, v46
    s_lshl_b32 s5, s3, 3
    v_mov_b32 v46, s5
    ds_write_b64 v46, v[44:45] offset:4608
    v_bfe_u32 v13, v0, 2, 3
    v_lshlrev_b32 v12, 7, v13
    v_lshrrev_b32 v13, 1, v13
    v_lshl_add_u32 v12, v13, 5, v12
    v_and_b32 v13, 3, v0
    v_lshl_add_u32 v12, v13, 3, v12
    v_bfe_u32 v13, v0, 5, 1
    v_lshl_add_u32 v12, v13, 11, v12
    v_add_u32 v12, s19, v12
    v_xor_b32 v13, 32, v12
    v_xor_b32 v14, 64, v12
    v_xor_b32 v15, 96, v12
    v_lshrrev_b32 v16, 1, v2
    v_lshlrev_b32 v16, 5, v16
    v_bfe_u32 v17, v0, 4, 1
    v_lshl_add_u32 v16, v17, 3, v16
    v_and_b32 v17, 1, v0
    v_lshl_add_u32 v16, v17, 2, v16
    s_mul_i32 s5, s3, 320
    s_add_u32 s5, s5, 1024
    v_add_u32 v16, s5, v16
    v_and_b32 v46, 7, v0
    v_mul_u32_u24 v17, 320, v46
    v_lshl_add_u32 v17, v3, 5, v17
    v_bfe_u32 v19, v0, 3, 1
    v_lshl_add_u32 v17, v19, 4, v17
    v_mul_u32_u24 v19, 0xaaaa, v19
    v_add_u32 v19, 0x4444, v19
    v_lshlrev_b32 v46, 3, v46
    s_waitcnt lgkmcnt(0)
    s_barrier
    ds_read_b64 v[46:47], v46 offset:4608
    s_waitcnt vmcnt(6)
    s_waitcnt vmcnt(5)
    s_waitcnt vmcnt(4)
    buffer_load_dwordx4 v[160:163], v4, s[32:35], s67 offen offset:3072 nt
    v_mov_b32 v50, 0
    s_waitcnt lgkmcnt(0)
    v_mov_b32 v48, v46
    s_nop 1
    v_max_f32_dpp v48, v48, v48 quad_perm:[1,0,3,2] row_mask:0xf bank_mask:0xf
    s_nop 1
    v_max_f32_dpp v48, v48, v48 quad_perm:[2,3,0,1] row_mask:0xf bank_mask:0xf
    s_nop 1
    v_max_f32_dpp v48, v48, v48 row_half_mirror row_mask:0xf bank_mask:0xf
    v_sub_f32 v46, v46, v48
    v_sub_f32 v44, v44, v48
    v_mul_f32 v46, s6, v46
    v_mul_f32 v44, s6, v44
    v_exp_f32 v46, v46
    v_exp_f32 v44, v44
    v_mul_f32 v49, v46, v47
    v_mul_f32 v52, v44, v52
    v_mul_f32 v53, v44, v53
    v_mul_f32 v54, v44, v54
    v_mul_f32 v55, v44, v55
    v_mul_f32 v56, v44, v56
    v_mul_f32 v57, v44, v57
    v_mul_f32 v58, v44, v58
    v_mul_f32 v59, v44, v59
    v_cvt_pk_bf16_f32 v52, v52, v52
    v_cvt_pk_bf16_f32 v53, v53, v53
    v_cvt_pk_bf16_f32 v54, v54, v54
    v_cvt_pk_bf16_f32 v55, v55, v55
    v_cvt_pk_bf16_f32 v56, v56, v56
    v_cvt_pk_bf16_f32 v57, v57, v57
    v_cvt_pk_bf16_f32 v58, v58, v58
    v_cvt_pk_bf16_f32 v59, v59, v59
    s_cmp_lg_u32 s3, 0
    s_cbranch_scc1 L_noml
    v_add_f32_dpp v49, v49, v49 quad_perm:[1,0,3,2] row_mask:0xf bank_mask:0xf
    s_nop 1
    v_add_f32_dpp v49, v49, v49 quad_perm:[2,3,0,1] row_mask:0xf bank_mask:0xf
    s_nop 1
    v_add_f32_dpp v49, v49, v49 row_half_mirror row_mask:0xf bank_mask:0xf
    s_mov_b32 s5, 0
L_flag:
    v_readfirstlane_b32 s4, v64
    s_add_u32 s5, s5, 1
    s_nop 0
    s_cmp_eq_u32 s4, 1
    s_cbranch_scc1 L_flag_ok
    s_cmp_ge_u32 s5, 65536
    s_cbranch_scc1 L_flag_ok
    buffer_load_dword v64, v50, s[56:59], 0 offen sc1
    s_waitcnt vmcnt(0)
    s_branch L_flag
L_flag_ok:
    v_or_b32 v49, s83, v49
    v_min_u32 v48, -2, v48
    v_min_u32 v49, -2, v49
    s_mov_b64 exec, 1
    buffer_store_dwordx2 v[48:49], v50, s[48:51], s80 offen sc1
    s_mov_b64 exec, -1
L_noml:
    s_lshl_b32 s6, s7, 9
    s_add_u32 s6, s6, 1048576
    v_lshlrev_b32 v45, 3, v1
    s_xor_b32 s27, s6, 1024
    v_and_b32_dpp v32, v52, v8 row_newbcast:0 row_mask:0xf bank_mask:0xf
    v_and_b32_dpp v33, v52, v9 row_newbcast:0 row_mask:0xf bank_mask:0xf
    v_and_b32_dpp v34, v52, v10 row_newbcast:0 row_mask:0xf bank_mask:0xf
    v_and_b32_dpp v35, v52, v11 row_newbcast:0 row_mask:0xf bank_mask:0xf
    s_nop 1
    v_mfma_f32_16x16x32_bf16 v[40:43], v[32:35], v[92:95], 0
    v_and_b32_dpp v36, v52, v8 row_newbcast:8 row_mask:0xf bank_mask:0xf
    v_and_b32_dpp v37, v52, v9 row_newbcast:8 row_mask:0xf bank_mask:0xf
    v_and_b32_dpp v38, v52, v10 row_newbcast:8 row_mask:0xf bank_mask:0xf
    v_and_b32_dpp v39, v52, v11 row_newbcast:8 row_mask:0xf bank_mask:0xf
    s_nop 1
    v_mfma_f32_16x16x32_bf16 v[40:43], v[36:39], v[96:99], v[40:43]
    v_and_b32_dpp v32, v52, v8 row_newbcast:4 row_mask:0xf bank_mask:0xf
    v_and_b32_dpp v33, v52, v9 row_newbcast:4 row_mask:0xf bank_mask:0xf
    v_and_b32_dpp v34, v52, v10 row_newbcast:4 row_mask:0xf bank_mask:0xf
    v_and_b32_dpp v35, v52, v11 row_newbcast:4 row_mask:0xf bank_mask:0xf
    s_nop 1
    v_mfma_f32_16x16x32_bf16 v[40:43], v[32:35], v[100:103], v[40:43]
    v_and_b32_dpp v36, v52, v8 row_newbcast:12 row_mask:0xf bank_mask:0xf
    v_and_b32_dpp v37, v52, v9 row_newbcast:12 row_mask:0xf bank_mask:0xf
    v_and_b32_dpp v38, v52, v10 row_newbcast:12 row_mask:0xf bank_mask:0xf
    v_and_b32_dpp v39, v52, v11 row_newbcast:12 row_mask:0xf bank_mask:0xf
    s_waitcnt vmcnt(4)
    buffer_load_dwordx4 v[172:175], v4, s[32:35], s68 offen offset:0 nt
    v_mfma_f32_16x16x32_bf16 v[40:43], v[36:39], v[112:115], v[40:43]
    v_and_b32_dpp v32, v53, v8 row_newbcast:0 row_mask:0xf bank_mask:0xf
    v_and_b32_dpp v33, v53, v9 row_newbcast:0 row_mask:0xf bank_mask:0xf
    v_and_b32_dpp v34, v53, v10 row_newbcast:0 row_mask:0xf bank_mask:0xf
    v_and_b32_dpp v35, v53, v11 row_newbcast:0 row_mask:0xf bank_mask:0xf
    s_waitcnt vmcnt(4)
    buffer_load_dwordx4 v[184:187], v4, s[32:35], s68 offen offset:1024 nt
    v_mfma_f32_16x16x32_bf16 v[40:43], v[32:35], v[124:127], v[40:43]
    v_and_b32_dpp v36, v53, v8 row_newbcast:8 row_mask:0xf bank_mask:0xf
    v_and_b32_dpp v37, v53, v9 row_newbcast:8 row_mask:0xf bank_mask:0xf
    v_and_b32_dpp v38, v53, v10 row_newbcast:8 row_mask:0xf bank_mask:0xf
    v_and_b32_dpp v39, v53, v11 row_newbcast:8 row_mask:0xf bank_mask:0xf
    s_waitcnt vmcnt(4)
    buffer_load_dwordx4 v[196:199], v4, s[32:35], s68 offen offset:2048 nt
    v_mfma_f32_16x16x32_bf16 v[40:43], v[36:39], v[136:139], v[40:43]
    v_and_b32_dpp v32, v53, v8 row_newbcast:4 row_mask:0xf bank_mask:0xf
    v_and_b32_dpp v33, v53, v9 row_newbcast:4 row_mask:0xf bank_mask:0xf
    v_and_b32_dpp v34, v53, v10 row_newbcast:4 row_mask:0xf bank_mask:0xf
    v_and_b32_dpp v35, v53, v11 row_newbcast:4 row_mask:0xf bank_mask:0xf
    s_waitcnt vmcnt(4)
    buffer_load_dwordx4 v[208:211], v4, s[32:35], s68 offen offset:3072 nt
    v_mfma_f32_16x16x32_bf16 v[40:43], v[32:35], v[148:151], v[40:43]
    v_and_b32_dpp v36, v53, v8 row_newbcast:12 row_mask:0xf bank_mask:0xf
    v_and_b32_dpp v37, v53, v9 row_newbcast:12 row_mask:0xf bank_mask:0xf
    v_and_b32_dpp v38, v53, v10 row_newbcast:12 row_mask:0xf bank_mask:0xf
    v_and_b32_dpp v39, v53, v11 row_newbcast:12 row_mask:0xf bank_mask:0xf
    s_waitcnt vmcnt(4)
    buffer_load_dwordx4 v[220:223], v4, s[32:35], s69 offen offset:0 nt
    v_mfma_f32_16x16x32_bf16 v[40:43], v[36:39], v[160:163], v[40:43]
    v_and_b32_dpp v32, v54, v8 row_newbcast:0 row_mask:0xf bank_mask:0xf
    v_and_b32_dpp v33, v54, v9 row_newbcast:0 row_mask:0xf bank_mask:0xf
    v_and_b32_dpp v34, v54, v10 row_newbcast:0 row_mask:0xf bank_mask:0xf
    v_and_b32_dpp v35, v54, v11 row_newbcast:0 row_mask:0xf bank_mask:0xf
    s_waitcnt vmcnt(4)
    buffer_load_dwordx4 v[232:235], v4, s[32:35], s69 offen offset:1024 nt
    v_mfma_f32_16x16x32_bf16 v[40:43], v[32:35], v[172:175], v[40:43]
    v_and_b32_dpp v36, v54, v8 row_newbcast:8 row_mask:0xf bank_mask:0xf
    v_and_b32_dpp v37, v54, v9 row_newbcast:8 row_mask:0xf bank_mask:0xf
    v_and_b32_dpp v38, v54, v10 row_newbcast:8 row_mask:0xf bank_mask:0xf
    v_and_b32_dpp v39, v54, v11 row_newbcast:8 row_mask:0xf bank_mask:0xf
    s_waitcnt vmcnt(4)
    buffer_load_dwordx4 v[68:71], v4, s[32:35], s69 offen offset:2048 nt
    v_mfma_f32_16x16x32_bf16 v[40:43], v[36:39], v[184:187], v[40:43]
    v_and_b32_dpp v32, v54, v8 row_newbcast:4 row_mask:0xf bank_mask:0xf
    v_and_b32_dpp v33, v54, v9 row_newbcast:4 row_mask:0xf bank_mask:0xf
    v_and_b32_dpp v34, v54, v10 row_newbcast:4 row_mask:0xf bank_mask:0xf
    v_and_b32_dpp v35, v54, v11 row_newbcast:4 row_mask:0xf bank_mask:0xf
    s_waitcnt vmcnt(4)
    buffer_load_dwordx4 v[72:75], v4, s[32:35], s69 offen offset:3072 nt
    v_mfma_f32_16x16x32_bf16 v[40:43], v[32:35], v[196:199], v[40:43]
    v_and_b32_dpp v36, v54, v8 row_newbcast:12 row_mask:0xf bank_mask:0xf
    v_and_b32_dpp v37, v54, v9 row_newbcast:12 row_mask:0xf bank_mask:0xf
    v_and_b32_dpp v38, v54, v10 row_newbcast:12 row_mask:0xf bank_mask:0xf
    v_and_b32_dpp v39, v54, v11 row_newbcast:12 row_mask:0xf bank_mask:0xf
    s_waitcnt vmcnt(4)
    buffer_load_dwordx4 v[76:79], v4, s[32:35], s70 offen offset:0 nt
    v_mfma_f32_16x16x32_bf16 v[40:43], v[36:39], v[208:211], v[40:43]
    v_and_b32_dpp v32, v55, v8 row_newbcast:0 row_mask:0xf bank_mask:0xf
    v_and_b32_dpp v33, v55, v9 row_newbcast:0 row_mask:0xf bank_mask:0xf
    v_and_b32_dpp v34, v55, v10 row_newbcast:0 row_mask:0xf bank_mask:0xf
    v_and_b32_dpp v35, v55, v11 row_newbcast:0 row_mask:0xf bank_mask:0xf
    s_waitcnt vmcnt(4)
    buffer_load_dwordx4 v[80:83], v4, s[32:35], s70 offen offset:1024 nt
    s_barrier
    s_add_u32 m0, s19, s74
    s_lshl_b32 s81, s74, 3
    buffer_load_dwordx4 v6, s[40:43], s81 offen offset:0 lds
    s_add_u32 s81, s81, 7168
    buffer_load_dwordx4 v6, s[40:43], s81 offen offset:1024 lds
    s_add_u32 s81, s81, 7168
    buffer_load_dwordx4 v6, s[40:43], s81 offen offset:2048 lds
    s_add_u32 s81, s81, 7168
    buffer_load_dwordx4 v6, s[40:43], s81 offen offset:3072 lds
    s_add_u32 m0, s19, s75
    s_lshl_b32 s81, s75, 3
    buffer_load_dwordx4 v6, s[40:43], s81 offen offset:0 lds
    s_add_u32 s81, s81, 7168
    buffer_load_dwordx4 v6, s[40:43], s81 offen offset:1024 lds
    s_add_u32 s81, s81, 7168
    buffer_load_dwordx4 v6, s[40:43], s81 offen offset:2048 lds
    s_add_u32 s81, s81, 7168
    buffer_load_dwordx4 v6, s[40:43], s81 offen offset:3072 lds
    s_add_u32 m0, s19, s76
    s_lshl_b32 s81, s76, 3
    buffer_load_dwordx4 v6, s[40:43], s81 offen offset:0 lds
    s_add_u32 s81, s81, 7168
    buffer_load_dwordx4 v6, s[40:43], s81 offen offset:1024 lds
    s_add_u32 s81, s81, 7168
    buffer_load_dwordx4 v6, s[40:43], s81 offen offset:2048 lds
    s_add_u32 s81, s81, 7168
    buffer_load_dwordx4 v6, s[40:43], s81 offen offset:3072 lds
    s_add_u32 m0, s19, s77
    s_lshl_b32 s81, s77, 3
    buffer_load_dwordx4 v6, s[40:43], s81 offen offset:0 lds
    s_add_u32 s81, s81, 7168
    buffer_load_dwordx4 v6, s[40:43], s81 offen offset:1024 lds
    s_add_u32 s81, s81, 7168
    buffer_load_dwordx4 v6, s[40:43], s81 offen offset:2048 lds
    s_add_u32 s81, s81, 7168
    buffer_load_dwordx4 v6, s[40:43], s81 offen offset:3072 lds
    v_mfma_f32_16x16x32_bf16 v[40:43], v[32:35], v[220:223], v[40:43]
    v_and_b32_dpp v36, v55, v8 row_newbcast:8 row_mask:0xf bank_mask:0xf
    v_and_b32_dpp v37, v55, v9 row_newbcast:8 row_mask:0xf bank_mask:0xf
    v_and_b32_dpp v38, v55, v10 row_newbcast:8 row_mask:0xf bank_mask:0xf
    v_and_b32_dpp v39, v55, v11 row_newbcast:8 row_mask:0xf bank_mask:0xf
    s_waitcnt vmcnt(20)
    buffer_load_dwordx4 v[104:107], v4, s[32:35], s70 offen offset:2048 nt
    v_mfma_f32_16x16x32_bf16 v[40:43], v[36:39], v[232:235], v[40:43]
    v_and_b32_dpp v32, v55, v8 row_newbcast:4 row_mask:0xf bank_mask:0xf
    v_and_b32_dpp v33, v55, v9 row_newbcast:4 row_mask:0xf bank_mask:0xf
    v_and_b32_dpp v34, v55, v10 row_newbcast:4 row_mask:0xf bank_mask:0xf
    v_and_b32_dpp v35, v55, v11 row_newbcast:4 row_mask:0xf bank_mask:0xf
    s_waitcnt vmcnt(20)
    buffer_load_dwordx4 v[108:111], v4, s[32:35], s70 offen offset:3072 nt
    v_mfma_f32_16x16x32_bf16 v[40:43], v[32:35], v[68:71], v[40:43]
    v_and_b32_dpp v36, v55, v8 row_newbcast:12 row_mask:0xf bank_mask:0xf
    v_and_b32_dpp v37, v55, v9 row_newbcast:12 row_mask:0xf bank_mask:0xf
    v_and_b32_dpp v38, v55, v10 row_newbcast:12 row_mask:0xf bank_mask:0xf
    v_and_b32_dpp v39, v55, v11 row_newbcast:12 row_mask:0xf bank_mask:0xf
    s_waitcnt vmcnt(20)
    buffer_load_dwordx4 v[116:119], v4, s[32:35], s71 offen offset:0 nt
    v_mfma_f32_16x16x32_bf16 v[40:43], v[36:39], v[72:75], v[40:43]
    v_and_b32_dpp v32, v56, v8 row_newbcast:0 row_mask:0xf bank_mask:0xf
    v_and_b32_dpp v33, v56, v9 row_newbcast:0 row_mask:0xf bank_mask:0xf
    v_and_b32_dpp v34, v56, v10 row_newbcast:0 row_mask:0xf bank_mask:0xf
    v_and_b32_dpp v35, v56, v11 row_newbcast:0 row_mask:0xf bank_mask:0xf
    s_waitcnt vmcnt(20)
    buffer_load_dwordx4 v[120:123], v4, s[32:35], s71 offen offset:1024 nt
    v_mfma_f32_16x16x32_bf16 v[40:43], v[32:35], v[76:79], v[40:43]
    v_and_b32_dpp v36, v56, v8 row_newbcast:8 row_mask:0xf bank_mask:0xf
    v_and_b32_dpp v37, v56, v9 row_newbcast:8 row_mask:0xf bank_mask:0xf
    v_and_b32_dpp v38, v56, v10 row_newbcast:8 row_mask:0xf bank_mask:0xf
    v_and_b32_dpp v39, v56, v11 row_newbcast:8 row_mask:0xf bank_mask:0xf
    s_waitcnt vmcnt(20)
    buffer_load_dwordx4 v[128:131], v4, s[32:35], s71 offen offset:2048 nt
    v_mfma_f32_16x16x32_bf16 v[40:43], v[36:39], v[80:83], v[40:43]
    v_and_b32_dpp v32, v56, v8 row_newbcast:4 row_mask:0xf bank_mask:0xf
    v_and_b32_dpp v33, v56, v9 row_newbcast:4 row_mask:0xf bank_mask:0xf
    v_and_b32_dpp v34, v56, v10 row_newbcast:4 row_mask:0xf bank_mask:0xf
    v_and_b32_dpp v35, v56, v11 row_newbcast:4 row_mask:0xf bank_mask:0xf
    s_waitcnt vmcnt(4)
    buffer_load_dwordx4 v[132:135], v4, s[32:35], s71 offen offset:3072 nt
    v_mfma_f32_16x16x32_bf16 v[40:43], v[32:35], v[104:107], v[40:43]
    ds_read_b64_tr_b16 v[80:81], v12 offset:0
    ds_read_b64_tr_b16 v[82:83], v12 offset:1024
    ds_read_b64_tr_b16 v[72:73], v13 offset:0
    ds_read_b64_tr_b16 v[74:75], v13 offset:1024
    ds_read_b64_tr_b16 v[232:233], v14 offset:0
    ds_read_b64_tr_b16 v[234:235], v14 offset:1024
    ds_read_b64_tr_b16 v[220:221], v15 offset:0
    ds_read_b64_tr_b16 v[222:223], v15 offset:1024
    v_and_b32_dpp v36, v56, v8 row_newbcast:12 row_mask:0xf bank_mask:0xf
    v_and_b32_dpp v37, v56, v9 row_newbcast:12 row_mask:0xf bank_mask:0xf
    v_and_b32_dpp v38, v56, v10 row_newbcast:12 row_mask:0xf bank_mask:0xf
    v_and_b32_dpp v39, v56, v11 row_newbcast:12 row_mask:0xf bank_mask:0xf
    s_waitcnt vmcnt(4)
    buffer_load_dwordx4 v[140:143], v4, s[32:35], s72 offen offset:0 nt
    v_mfma_f32_16x16x32_bf16 v[40:43], v[36:39], v[108:111], v[40:43]
    ds_read_b64_tr_b16 v[84:85], v12 offset:4096
    ds_read_b64_tr_b16 v[86:87], v12 offset:5120
    ds_read_b64_tr_b16 v[76:77], v13 offset:4096
    ds_read_b64_tr_b16 v[78:79], v13 offset:5120
    ds_read_b64_tr_b16 v[236:237], v14 offset:4096
    ds_read_b64_tr_b16 v[238:239], v14 offset:5120
    ds_read_b64_tr_b16 v[224:225], v15 offset:4096
    ds_read_b64_tr_b16 v[226:227], v15 offset:5120
    v_and_b32_dpp v32, v57, v8 row_newbcast:0 row_mask:0xf bank_mask:0xf
    v_and_b32_dpp v33, v57, v9 row_newbcast:0 row_mask:0xf bank_mask:0xf
    v_and_b32_dpp v34, v57, v10 row_newbcast:0 row_mask:0xf bank_mask:0xf
    v_and_b32_dpp v35, v57, v11 row_newbcast:0 row_mask:0xf bank_mask:0xf
    s_waitcnt vmcnt(4)
    buffer_load_dwordx4 v[144:147], v4, s[32:35], s72 offen offset:1024 nt
    v_mfma_f32_16x16x32_bf16 v[40:43], v[32:35], v[116:119], v[40:43]
    ds_read_b64_tr_b16 v[108:109], v12 offset:8192
    ds_read_b64_tr_b16 v[110:111], v12 offset:9216
    ds_read_b64_tr_b16 v[208:209], v13 offset:8192
    ds_read_b64_tr_b16 v[210:211], v13 offset:9216
    ds_read_b64_tr_b16 v[196:197], v14 offset:8192
    ds_read_b64_tr_b16 v[198:199], v14 offset:9216
    ds_read_b64_tr_b16 v[184:185], v15 offset:8192
    ds_read_b64_tr_b16 v[186:187], v15 offset:9216
    s_cmp_lg_u32 s3, 0
    s_cbranch_scc1 L_nomlpre
    buffer_load_dwordx2 v[48:49], v45, s[48:51], s6 offen sc1
    buffer_load_dwordx2 v[20:21], v45, s[48:51], s27 offen sc1
    v_mov_b32 v47, 1
    s_lshl_b32 s4, s7, 6
    s_mov_b64 exec, 1
    buffer_atomic_add v47, v50, s[56:59], s4 offen offset:32 sc0 sc1
    s_mov_b64 exec, -1
L_nomlpre:
    s_nop 1
    v_and_b32_dpp v36, v57, v8 row_newbcast:8 row_mask:0xf bank_mask:0xf
    v_and_b32_dpp v37, v57, v9 row_newbcast:8 row_mask:0xf bank_mask:0xf
    v_and_b32_dpp v38, v57, v10 row_newbcast:8 row_mask:0xf bank_mask:0xf
    v_and_b32_dpp v39, v57, v11 row_newbcast:8 row_mask:0xf bank_mask:0xf
    s_waitcnt vmcnt(4)
    buffer_load_dwordx4 v[152:155], v4, s[32:35], s72 offen offset:2048 nt
    v_mfma_f32_16x16x32_bf16 v[40:43], v[36:39], v[120:123], v[40:43]
    v_mov_b32 v120, 0
    v_mov_b32 v121, 0
    v_mov_b32 v122, 0
    v_mov_b32 v123, 0
    ds_read_b64_tr_b16 v[112:113], v12 offset:12288
    ds_read_b64_tr_b16 v[114:115], v12 offset:13312
    v_mov_b32 v116, 0
    v_mov_b32 v117, 0
    v_mov_b32 v118, 0
    v_mov_b32 v119, 0
    ds_read_b64_tr_b16 v[212:213], v13 offset:12288
    ds_read_b64_tr_b16 v[214:215], v13 offset:13312
    v_mov_b32 v104, 0
    v_mov_b32 v105, 0
    v_mov_b32 v106, 0
    v_mov_b32 v107, 0
    ds_read_b64_tr_b16 v[200:201], v14 offset:12288
    ds_read_b64_tr_b16 v[202:203], v14 offset:13312
    v_mov_b32 v68, 0
    v_mov_b32 v69, 0
    v_mov_b32 v70, 0
    v_mov_b32 v71, 0
    ds_read_b64_tr_b16 v[188:189], v15 offset:12288
    ds_read_b64_tr_b16 v[190:191], v15 offset:13312
    v_and_b32_dpp v32, v57, v8 row_newbcast:4 row_mask:0xf bank_mask:0xf
    v_and_b32_dpp v33, v57, v9 row_newbcast:4 row_mask:0xf bank_mask:0xf
    v_and_b32_dpp v34, v57, v10 row_newbcast:4 row_mask:0xf bank_mask:0xf
    v_and_b32_dpp v35, v57, v11 row_newbcast:4 row_mask:0xf bank_mask:0xf
    s_waitcnt vmcnt(4)
    buffer_load_dwordx4 v[156:159], v4, s[32:35], s72 offen offset:3072 nt
    v_mfma_f32_16x16x32_bf16 v[40:43], v[32:35], v[128:131], v[40:43]
    v_and_b32_dpp v36, v57, v8 row_newbcast:12 row_mask:0xf bank_mask:0xf
    v_and_b32_dpp v37, v57, v9 row_newbcast:12 row_mask:0xf bank_mask:0xf
    v_and_b32_dpp v38, v57, v10 row_newbcast:12 row_mask:0xf bank_mask:0xf
    v_and_b32_dpp v39, v57, v11 row_newbcast:12 row_mask:0xf bank_mask:0xf
    s_waitcnt vmcnt(4)
    buffer_load_dwordx4 v[164:167], v4, s[32:35], s73 offen offset:0 nt
    v_mfma_f32_16x16x32_bf16 v[40:43], v[36:39], v[132:135], v[40:43]
    v_and_b32_dpp v32, v58, v8 row_newbcast:0 row_mask:0xf bank_mask:0xf
    v_and_b32_dpp v33, v58, v9 row_newbcast:0 row_mask:0xf bank_mask:0xf
    v_and_b32_dpp v34, v58, v10 row_newbcast:0 row_mask:0xf bank_mask:0xf
    v_and_b32_dpp v35, v58, v11 row_newbcast:0 row_mask:0xf bank_mask:0xf
    s_waitcnt vmcnt(4)
    buffer_load_dwordx4 v[168:171], v4, s[32:35], s73 offen offset:1024 nt
    v_mfma_f32_16x16x32_bf16 v[40:43], v[32:35], v[140:143], v[40:43]
    v_and_b32_dpp v36, v58, v8 row_newbcast:8 row_mask:0xf bank_mask:0xf
    v_and_b32_dpp v37, v58, v9 row_newbcast:8 row_mask:0xf bank_mask:0xf
    v_and_b32_dpp v38, v58, v10 row_newbcast:8 row_mask:0xf bank_mask:0xf
    v_and_b32_dpp v39, v58, v11 row_newbcast:8 row_mask:0xf bank_mask:0xf
    s_waitcnt vmcnt(4)
    buffer_load_dwordx4 v[176:179], v4, s[32:35], s73 offen offset:2048 nt
    v_mfma_f32_16x16x32_bf16 v[40:43], v[36:39], v[144:147], v[40:43]
    v_and_b32_dpp v32, v58, v8 row_newbcast:4 row_mask:0xf bank_mask:0xf
    v_and_b32_dpp v33, v58, v9 row_newbcast:4 row_mask:0xf bank_mask:0xf
    v_and_b32_dpp v34, v58, v10 row_newbcast:4 row_mask:0xf bank_mask:0xf
    v_and_b32_dpp v35, v58, v11 row_newbcast:4 row_mask:0xf bank_mask:0xf
    s_waitcnt vmcnt(4)
    buffer_load_dwordx4 v[180:183], v4, s[32:35], s73 offen offset:3072 nt
    v_mfma_f32_16x16x32_bf16 v[40:43], v[32:35], v[152:155], v[40:43]
    v_and_b32_dpp v36, v58, v8 row_newbcast:12 row_mask:0xf bank_mask:0xf
    v_and_b32_dpp v37, v58, v9 row_newbcast:12 row_mask:0xf bank_mask:0xf
    v_and_b32_dpp v38, v58, v10 row_newbcast:12 row_mask:0xf bank_mask:0xf
    v_and_b32_dpp v39, v58, v11 row_newbcast:12 row_mask:0xf bank_mask:0xf
    s_waitcnt vmcnt(4)
    s_nop 0
    v_mfma_f32_16x16x32_bf16 v[40:43], v[36:39], v[156:159], v[40:43]
    v_and_b32_dpp v32, v59, v8 row_newbcast:0 row_mask:0xf bank_mask:0xf
    v_and_b32_dpp v33, v59, v9 row_newbcast:0 row_mask:0xf bank_mask:0xf
    v_and_b32_dpp v34, v59, v10 row_newbcast:0 row_mask:0xf bank_mask:0xf
    v_and_b32_dpp v35, v59, v11 row_newbcast:0 row_mask:0xf bank_mask:0xf
    s_waitcnt vmcnt(3)
    s_nop 0
    v_mfma_f32_16x16x32_bf16 v[40:43], v[32:35], v[164:167], v[40:43]
    v_and_b32_dpp v36, v59, v8 row_newbcast:8 row_mask:0xf bank_mask:0xf
    v_and_b32_dpp v37, v59, v9 row_newbcast:8 row_mask:0xf bank_mask:0xf
    v_and_b32_dpp v38, v59, v10 row_newbcast:8 row_mask:0xf bank_mask:0xf
    v_and_b32_dpp v39, v59, v11 row_newbcast:8 row_mask:0xf bank_mask:0xf
    s_waitcnt vmcnt(2)
    s_nop 0
    v_mfma_f32_16x16x32_bf16 v[40:43], v[36:39], v[168:171], v[40:43]
    v_and_b32_dpp v32, v59, v8 row_newbcast:4 row_mask:0xf bank_mask:0xf
    v_and_b32_dpp v33, v59, v9 row_newbcast:4 row_mask:0xf bank_mask:0xf
    v_and_b32_dpp v34, v59, v10 row_newbcast:4 row_mask:0xf bank_mask:0xf
    v_and_b32_dpp v35, v59, v11 row_newbcast:4 row_mask:0xf bank_mask:0xf
    s_waitcnt vmcnt(1)
    s_nop 0
    v_mfma_f32_16x16x32_bf16 v[40:43], v[32:35], v[176:179], v[40:43]
    v_and_b32_dpp v36, v59, v8 row_newbcast:12 row_mask:0xf bank_mask:0xf
    v_and_b32_dpp v37, v59, v9 row_newbcast:12 row_mask:0xf bank_mask:0xf
    v_and_b32_dpp v38, v59, v10 row_newbcast:12 row_mask:0xf bank_mask:0xf
    v_and_b32_dpp v39, v59, v11 row_newbcast:12 row_mask:0xf bank_mask:0xf
    s_waitcnt vmcnt(0)
    s_nop 0
    v_mfma_f32_16x16x32_bf16 v[40:43], v[36:39], v[180:183], v[40:43]
    s_nop 7
    v_cvt_pk_bf16_f32 v40, v40, v41
    v_cvt_pk_bf16_f32 v41, v42, v43
    ds_write2_b32 v16, v40, v41 offset0:0 offset1:4
    s_mov_b32 s82, 0
    s_cmp_lg_u32 s3, 0
    s_cbranch_scc1 L_nocons
L_ml:
    v_max_u32 v18, v48, v49
    v_max3_u32 v18, v18, v20, v21
    v_cmp_eq_u32 vcc, -1, v18
    s_add_u32 s82, s82, 1
    s_nop 1
    s_cbranch_vccz L_ml_ok
    s_cmp_ge_u32 s82, 65536
    s_cbranch_scc1 L_ml_ok
    buffer_load_dwordx2 v[48:49], v45, s[48:51], s6 offen sc1
    buffer_load_dwordx2 v[20:21], v45, s[48:51], s27 offen sc1
    s_waitcnt vmcnt(0)
    s_branch L_ml
L_ml_ok:
    v_cmp_gt_i32 vcc, 0, v49
    v_cmp_gt_i32 s[26:27], 0, v21
    v_and_b32 v49, 0x7fffffff, v49
    s_bcnt1_i32_b64 s83, vcc
    s_bcnt1_i32_b64 s26, s[26:27]
    s_add_u32 s83, s83, s26
    s_cmp_gt_u32 s83, 16
    s_cselect_b32 s26, 0x2000, 0
    v_max_f32_dpp v6, v48, v48 quad_perm:[1,0,3,2] row_mask:0xf bank_mask:0xf
    v_sub_f32 v4, v48, v6
    v_mul_f32 v4, 0x3fb8aa3b, v4
    v_exp_f32 v4, v4
    s_nop 0
    v_mul_f32 v5, v49, v4
    s_nop 1
    v_add_f32_dpp v5, v5, v5 quad_perm:[1,0,3,2] row_mask:0xf bank_mask:0xf
    v_rcp_f32 v5, v5
    v_readfirstlane_b32 s4, v47
    s_nop 1
    s_sub_u32 s4, s4, 0
    v_mul_f32 v4, v4, v5
    s_and_b32 s4, s4, 0xff
    s_or_b32 s4, s4, s26
    v_mov_b32 v5, s4
    ds_write_b64 v45, v[4:5] offset:0
L_nocons:
    s_waitcnt lgkmcnt(0)
    s_barrier
    ds_read_b128 v[52:55], v17 offset:1024
    ds_read_b128 v[56:59], v17 offset:1152
    v_and_b32 v5, 0x1f8, v0
    ds_read_b64 v[4:5], v5 offset:0
    s_waitcnt lgkmcnt(2)
    v_smfmac_f32_16x16x64_bf16 v[120:123], v[52:55], v[80:87], v19
    v_smfmac_f32_16x16x64_bf16 v[116:119], v[52:55], v[72:79], v19
    v_smfmac_f32_16x16x64_bf16 v[104:107], v[52:55], v[232:239], v19
    v_smfmac_f32_16x16x64_bf16 v[68:71], v[52:55], v[220:227], v19
    s_waitcnt lgkmcnt(1)
    v_smfmac_f32_16x16x64_bf16 v[120:123], v[56:59], v[108:115], v19
    v_smfmac_f32_16x16x64_bf16 v[116:119], v[56:59], v[208:215], v19
    v_smfmac_f32_16x16x64_bf16 v[104:107], v[56:59], v[196:203], v19
    v_smfmac_f32_16x16x64_bf16 v[68:71], v[56:59], v[184:191], v19
    s_waitcnt lgkmcnt(0)
    v_readfirstlane_b32 s78, v5
    s_nop 1
    s_and_b32 s26, s78, 0x2000
    s_and_b32 s78, s78, 0xff
    s_xor_b32 s79, s79, s26
    v_pk_add_f32 v[120:121], v[120:121], v[122:123]
    v_pk_add_f32 v[116:117], v[116:117], v[118:119]
    v_pk_add_f32 v[104:105], v[104:105], v[106:107]
    v_pk_add_f32 v[68:69], v[68:69], v[70:71]
    v_add_f32 v120, v120, v121
    v_add_f32 v116, v116, v117
    v_add_f32 v104, v104, v105
    v_add_f32 v68, v68, v69
    v_permlane16_swap_b32 v120, v116
    s_nop 0
    v_permlane16_swap_b32 v104, v68
    v_add_f32 v24, v120, v116
    v_add_f32 v25, v104, v68
    s_nop 1
    v_permlane32_swap_b32 v24, v25
    v_add_f32 v24, v24, v25
    v_min_u32 v24, -2, v24
    buffer_store_dword v24, v65, s[48:51], s79 offen sc1
    v_lshrrev_b32 v46, 3, v0
    v_and_b32 v3, 7, v0
    s_cmp_ge_u32 s78, 16
    s_cbranch_scc1 L_end
    v_and_b32 v18, -4, v46
    v_add_u32 v46, v46, v18
    v_lshlrev_b32 v46, 11, v46
    v_lshl_add_u32 v46, v3, 4, v46
    s_and_b32 s5, s79, 0x42000
    s_lshl_b32 s4, s78, 7
    s_add_u32 s5, s5, s4
    v_mov_b32 v180, -1
    v_mov_b32 v181, -1
    v_mov_b32 v182, -1
    v_mov_b32 v183, -1
    buffer_load_dwordx4 v[180:183], v46, s[48:51], s5 offen sc1
    v_lshlrev_b32 v3, 2, v3
    v_bfe_u32 v18, v0, 4, 1
    v_lshl_add_u32 v3, v18, 1, v3
    v_bfe_u32 v18, v0, 5, 1
    v_add_lshl_u32 v3, v3, v18, 5
    v_lshl_add_u32 v3, v7, 2, v3
    v_lshlrev_b32 v6, 4, v1
    v_and_b32 v5, 62, v1
    s_lshl_b32 s24, s63, 11
    s_lshl_b32 s25, s61, 10
    s_add_u32 s24, s24, s25
    s_lshr_b32 s4, s4, 1
    s_add_u32 s24, s24, s4
L_y:
    s_waitcnt vmcnt(1)
    v_max3_u32 v18, v180, v181, v182
    v_max_u32 v18, v18, v183
    v_cmp_eq_u32 vcc, -1, v18
    s_add_u32 s82, s82, 1
    s_nop 1
    s_cbranch_vccz L_y_ok
    s_mov_b64 exec, vcc
    buffer_load_dwordx4 v[180:183], v46, s[48:51], s5 offen sc1
    s_cmp_lt_u32 s82, 65536
    s_cbranch_scc1 L_y
L_y_ok:
    s_mov_b64 exec, -1
    v_mul_f32 v24, v4, v180
    v_mul_f32 v25, v4, v181
    v_mul_f32 v26, v4, v182
    v_mul_f32 v27, v4, v183
    v_permlane32_swap_b32 v24, v25
    s_nop 0
    v_permlane32_swap_b32 v26, v27
    v_add_f32 v24, v24, v25
    v_add_f32 v26, v26, v27
    s_nop 1
    v_permlane16_swap_b32 v24, v26
    v_add_f32 v24, v24, v26
    s_nop 1
    v_add_f32_dpp v24, v24, v24 row_ror:8 row_mask:0xf bank_mask:0xf
    ds_write_b32 v3, v24 offset:7168
    s_cmp_lg_u32 s3, 0
    s_waitcnt lgkmcnt(0)
    s_barrier
    s_cbranch_scc1 L_end
    ds_read_b128 v[24:27], v6 offset:7168
    s_waitcnt lgkmcnt(0)
    v_pk_add_f32 v[24:25], v[24:25], v[26:27]
    v_add_f32 v24, v24, v25
    s_nop 1
    v_add_f32_dpp v24, v24, v24 quad_perm:[1,0,3,2] row_mask:0xf bank_mask:0xf
    v_cvt_pk_bf16_f32 v24, v24, v24
    buffer_store_short v24, v5, s[52:55], s24 offen
L_end:
    s_endpgm
M_alt:
    v_readfirstlane_b32 s3, v7
    s_bfe_u32 s63, s2, 0x10004
    s_mov_b32 s50, 0x1000000
    s_mov_b32 s51, s31
    s_lshl1_add_u32 s7, s61, s63
    s_lshl1_add_u32 s78, s62, s64
    s_lshl_b32 s80, s7, 6
    s_add_u32 s80, s80, s78
    s_and_b32 s83, s80, 127
    s_andn2_b32 s79, s83, 3
    s_add_u32 s79, s79, s83
    s_lshl2_add_u32 s79, s61, s79
    s_lshl_b32 s79, s79, 11
    s_mov_b32 s83, 0
    v_lshlrev_b32 v65, 2, v0
    v_mov_b32 v44, -1
    s_waitcnt lgkmcnt(0)
    s_mov_b32 s48, s24
    s_mov_b32 s49, s25
    s_lshl3_add_u32 s6, s2, s3
    s_mov_b32 s4, 1048576
    s_lshl3_add_u32 s80, s80, s4
    v_and_b32 v1, 63, v0
    s_cmp_lg_u32 s6, 1
    s_cbranch_scc1 M_nopoison
    v_mov_b32 v45, -1
    v_mov_b32 v46, -1
    v_mov_b32 v47, -1
    v_lshlrev_b32 v48, 4, v1
    buffer_store_dwordx4 v[44:47], v48, s[48:51], s4 offen sc1
    buffer_store_dwordx4 v[44:47], v48, s[48:51], s4 offen offset:1024 sc1
M_nopoison:
    s_waitcnt vmcnt(7)
    v_lshlrev_b32 v61, 5, v3
    v_lshl_add_u32 v61, v7, 7, v61
    s_lshl_b32 s27, s63, 10
    s_add_u32 s44, s8, s27
    s_addc_u32 s45, s9, 0
    s_movk_i32 s46, 0x400
    s_mov_b32 s47, s31
    s_lshr_b32 s4, s74, 9
    buffer_load_dwordx2 v[20:21], v61, s[44:47], s4 offen
    s_lshr_b32 s4, s75, 9
    buffer_load_dwordx2 v[22:23], v61, s[44:47], s4 offen
    s_lshr_b32 s4, s76, 9
    buffer_load_dwordx2 v[24:25], v61, s[44:47], s4 offen
    s_lshr_b32 s4, s77, 9
    buffer_load_dwordx2 v[26:27], v61, s[44:47], s4 offen
    s_waitcnt vmcnt(10)
    s_add_u32 s32, s12, s18
    s_addc_u32 s33, s13, 0
    s_mov_b32 s34, s30
    s_mov_b32 s35, s31
    s_lshl_b32 s26, s62, 17
    s_add_u32 s40, s16, s26
    s_addc_u32 s41, s17, 0
    s_mov_b32 s42, s31
    s_mov_b32 s43, s31
    s_mov_b32 s52, s20
    s_mov_b32 s53, s21
    s_movk_i32 s54, 0x1000
    s_mov_b32 s55, s31
    s_mov_b32 s56, s22
    s_mov_b32 s57, s23
    s_movk_i32 s58, 0x100
    s_mov_b32 s59, s31
    s_waitcnt vmcnt(9)
    v_and_b32 v60, 1, v2
    v_lshlrev_b32 v60, 4, v60
    v_mov_b32 v62, 0xffff
    v_lshlrev_b32 v62, v60, v62
    v_bfe_u32 v60, v0, 1, 2
    v_cmp_eq_u32 vcc, 0, v60
    s_nop 1
    v_cndmask_b32 v8, 0, v62, vcc
    v_cmp_eq_u32 vcc, 1, v60
    s_nop 1
    v_cndmask_b32 v9, 0, v62, vcc
    v_cmp_eq_u32 vcc, 2, v60
    s_nop 1
    v_cndmask_b32 v10, 0, v62, vcc
    v_cmp_eq_u32 vcc, 3, v60
    s_nop 1
    v_cndmask_b32 v11, 0, v62, vcc
    s_waitcnt vmcnt(8)
    s_mov_b32 s4, 0x0c0c0c0c
    v_mov_b32 v60, 0x01000100
    v_mov_b32 v62, 0x03020302
    v_bfi_b32 v12, v8, v60, s4
    v_bfi_b32 v16, v8, v62, s4
    v_bfi_b32 v13, v9, v60, s4
    v_bfi_b32 v17, v9, v62, s4
    v_bfi_b32 v14, v10, v60, s4
    v_bfi_b32 v18, v10, v62, s4
    v_bfi_b32 v15, v11, v60, s4
    v_bfi_b32 v19, v11, v62, s4
    s_waitcnt vmcnt(7)
    v_lshlrev_b32 v60, 1, v3
    v_and_b32 v6, 7, v0
    v_xor_b32 v6, v6, v60
    v_lshlrev_b32 v6, 4, v6
    v_bfe_u32 v60, v0, 3, 3
    v_lshl_add_u32 v6, v60, 10, v6
    v_lshl_add_u32 v6, v7, 7, v6
    s_lshl_b32 s19, s3, 14
    s_add_u32 s19, s19, 8192
    s_waitcnt vmcnt(6)
    v_lshlrev_b32 v60, 5, v2
    v_lshl_add_u32 v60, v3, 4, v60
    s_mul_i32 s5, s3, 528
    v_add_u32 v60, s5, v60
    v_and_b32 v61, 3, v0
    v_mul_u32_u24 v61, 1056, v61
    v_lshrrev_b32 v62, 2, v0
    v_lshl_add_u32 v61, v62, 2, v61
    v_lshlrev_b32 v62, 1, v62
    s_waitcnt vmcnt(5)
    s_waitcnt vmcnt(4)
    s_lshl_b32 s81, s75, 3
    buffer_load_dwordx4 v[100:103], v5, s[36:39], s81 offen
    buffer_load_dwordx4 v[104:107], v4, s[28:31], s67 offen offset:0 nt
    buffer_load_dwordx4 v[108:111], v4, s[28:31], s67 offen offset:1024 nt
    s_add_u32 s81, s81, 0x2000
    buffer_load_dwordx4 v[112:115], v5, s[36:39], s81 offen
    buffer_load_dwordx4 v[116:119], v4, s[28:31], s67 offen offset:2048 nt
    buffer_load_dwordx4 v[120:123], v4, s[28:31], s67 offen offset:3072 nt
    s_add_u32 s81, s81, 0x2000
    buffer_load_dwordx4 v[124:127], v5, s[36:39], s81 offen
    buffer_load_dwordx4 v[128:131], v4, s[28:31], s68 offen offset:0 nt
    buffer_load_dwordx4 v[132:135], v4, s[28:31], s68 offen offset:1024 nt
    s_add_u32 s81, s81, 0x2000
    buffer_load_dwordx4 v[136:139], v5, s[36:39], s81 offen
    s_waitcnt vmcnt(10)
    v_perm_b32 v32, v20, v20, v12
    v_perm_b32 v33, v20, v20, v13
    v_perm_b32 v34, v20, v20, v14
    v_perm_b32 v35, v20, v20, v15
    s_nop 1
    v_mfma_f32_16x16x32_bf16 v[40:43], v[32:35], v[84:87], 0
    v_perm_b32 v36, v20, v20, v16
    v_perm_b32 v37, v20, v20, v17
    v_perm_b32 v38, v20, v20, v18
    v_perm_b32 v39, v20, v20, v19
    s_nop 1
    v_mfma_f32_16x16x32_bf16 v[40:43], v[36:39], v[88:91], v[40:43]
    v_perm_b32 v32, v21, v21, v12
    v_perm_b32 v33, v21, v21, v13
    v_perm_b32 v34, v21, v21, v14
    v_perm_b32 v35, v21, v21, v15
    s_nop 1
    v_mfma_f32_16x16x32_bf16 v[40:43], v[32:35], v[92:95], v[40:43]
    v_perm_b32 v36, v21, v21, v16
    v_perm_b32 v37, v21, v21, v17
    v_perm_b32 v38, v21, v21, v18
    v_perm_b32 v39, v21, v21, v19
    s_nop 1
    v_mfma_f32_16x16x32_bf16 v[40:43], v[36:39], v[96:99], v[40:43]
    v_perm_b32 v32, v22, v22, v12
    v_perm_b32 v33, v22, v22, v13
    v_perm_b32 v34, v22, v22, v14
    v_perm_b32 v35, v22, v22, v15
    s_waitcnt vmcnt(9)
    s_cmp_lg_u32 s6, 1
    s_cbranch_scc1 M_nosignal
    v_mov_b32 v48, 1
    v_mov_b32 v49, 0
    s_mov_b64 exec, 1
    buffer_store_dword v48, v49, s[56:59], 0 offen sc1
    s_mov_b64 exec, -1
M_nosignal:
    s_nop 1
    v_mfma_f32_16x16x32_bf16 v[40:43], v[32:35], v[100:103], v[40:43]
    v_perm_b32 v36, v22, v22, v16
    v_perm_b32 v37, v22, v22, v17
    v_perm_b32 v38, v22, v22, v18
    v_perm_b32 v39, v22, v22, v19
    s_waitcnt vmcnt(8)
    buffer_load_dwordx4 v[140:143], v4, s[28:31], s68 offen offset:2048 nt
    s_waitcnt vmcnt(8)
    buffer_load_dwordx4 v[144:147], v4, s[28:31], s68 offen offset:3072 nt
    s_lshl_b32 s81, s76, 3
    buffer_load_dwordx4 v[148:151], v5, s[36:39], s81 offen
    s_waitcnt vmcnt(9)
    v_mfma_f32_16x16x32_bf16 v[40:43], v[36:39], v[112:115], v[40:43]
    v_perm_b32 v32, v23, v23, v12
    v_perm_b32 v33, v23, v23, v13
    v_perm_b32 v34, v23, v23, v14
    v_perm_b32 v35, v23, v23, v15
    s_waitcnt vmcnt(8)
    buffer_load_dwordx4 v[152:155], v4, s[28:31], s69 offen offset:0 nt
    s_waitcnt vmcnt(8)
    buffer_load_dwordx4 v[156:159], v4, s[28:31], s69 offen offset:1024 nt
    s_add_u32 s81, s81, 0x2000
    buffer_load_dwordx4 v[160:163], v5, s[36:39], s81 offen
    s_waitcnt vmcnt(9)
    v_mfma_f32_16x16x32_bf16 v[40:43], v[32:35], v[124:127], v[40:43]
    v_perm_b32 v36, v23, v23, v16
    v_perm_b32 v37, v23, v23, v17
    v_perm_b32 v38, v23, v23, v18
    v_perm_b32 v39, v23, v23, v19
    s_waitcnt vmcnt(8)
    buffer_load_dwordx4 v[164:167], v4, s[28:31], s69 offen offset:2048 nt
    s_waitcnt vmcnt(8)
    buffer_load_dwordx4 v[168:171], v4, s[28:31], s69 offen offset:3072 nt
    s_add_u32 s81, s81, 0x2000
    buffer_load_dwordx4 v[172:175], v5, s[36:39], s81 offen
    s_waitcnt vmcnt(9)
    v_mfma_f32_16x16x32_bf16 v[40:43], v[36:39], v[136:139], v[40:43]
    v_perm_b32 v32, v24, v24, v12
    v_perm_b32 v33, v24, v24, v13
    v_perm_b32 v34, v24, v24, v14
    v_perm_b32 v35, v24, v24, v15
    s_waitcnt vmcnt(8)
    buffer_load_dwordx4 v[176:179], v4, s[28:31], s70 offen offset:0 nt
    s_waitcnt vmcnt(8)
    buffer_load_dwordx4 v[180:183], v4, s[28:31], s70 offen offset:1024 nt
    s_add_u32 s81, s81, 0x2000
    buffer_load_dwordx4 v[184:187], v5, s[36:39], s81 offen
    s_waitcnt vmcnt(9)
    v_mfma_f32_16x16x32_bf16 v[40:43], v[32:35], v[148:151], v[40:43]
    s_cmp_ge_u32 s3, 4
    s_cbranch_scc1 M_noyp
    v_mov_b32 v44, -1
    v_mov_b32 v45, -1
    v_mov_b32 v46, -1
    v_mov_b32 v47, -1
    v_lshlrev_b32 v48, 3, v0
    buffer_store_dwordx2 v[44:45], v48, s[48:51], s79 offen sc1
M_noyp:
    v_perm_b32 v36, v24, v24, v16
    v_perm_b32 v37, v24, v24, v17
    v_perm_b32 v38, v24, v24, v18
    v_perm_b32 v39, v24, v24, v19
    s_waitcnt vmcnt(8)
    buffer_load_dwordx4 v[188:191], v4, s[28:31], s70 offen offset:2048 nt
    s_waitcnt vmcnt(8)
    buffer_load_dwordx4 v[192:195], v4, s[28:31], s70 offen offset:3072 nt
    s_lshl_b32 s81, s77, 3
    buffer_load_dwordx4 v[196:199], v5, s[36:39], s81 offen
    s_waitcnt vmcnt(9)
    v_mfma_f32_16x16x32_bf16 v[40:43], v[36:39], v[160:163], v[40:43]
    v_perm_b32 v32, v25, v25, v12
    v_perm_b32 v33, v25, v25, v13
    v_perm_b32 v34, v25, v25, v14
    v_perm_b32 v35, v25, v25, v15
    s_waitcnt vmcnt(8)
    buffer_load_dwordx4 v[200:203], v4, s[28:31], s71 offen offset:0 nt
    s_waitcnt vmcnt(8)
    buffer_load_dwordx4 v[204:207], v4, s[28:31], s71 offen offset:1024 nt
    s_add_u32 s81, s81, 0x2000
    buffer_load_dwordx4 v[208:211], v5, s[36:39], s81 offen
    s_waitcnt vmcnt(9)
    v_mfma_f32_16x16x32_bf16 v[40:43], v[32:35], v[172:175], v[40:43]
    v_perm_b32 v36, v25, v25, v16
    v_perm_b32 v37, v25, v25, v17
    v_perm_b32 v38, v25, v25, v18
    v_perm_b32 v39, v25, v25, v19
    s_waitcnt vmcnt(8)
    buffer_load_dwordx4 v[212:215], v4, s[28:31], s71 offen offset:2048 nt
    s_waitcnt vmcnt(8)
    buffer_load_dwordx4 v[216:219], v4, s[28:31], s71 offen offset:3072 nt
    s_add_u32 s81, s81, 0x2000
    buffer_load_dwordx4 v[220:223], v5, s[36:39], s81 offen
    s_waitcnt vmcnt(9)
    v_mfma_f32_16x16x32_bf16 v[40:43], v[36:39], v[184:187], v[40:43]
    v_perm_b32 v32, v26, v26, v12
    v_perm_b32 v33, v26, v26, v13
    v_perm_b32 v34, v26, v26, v14
    v_perm_b32 v35, v26, v26, v15
    s_waitcnt vmcnt(8)
    buffer_load_dwordx4 v[224:227], v4, s[28:31], s72 offen offset:0 nt
    s_waitcnt vmcnt(8)
    buffer_load_dwordx4 v[228:231], v4, s[28:31], s72 offen offset:1024 nt
    s_add_u32 s81, s81, 0x2000
    buffer_load_dwordx4 v[232:235], v5, s[36:39], s81 offen
    s_waitcnt vmcnt(9)
    v_mfma_f32_16x16x32_bf16 v[40:43], v[32:35], v[196:199], v[40:43]
    s_cmp_lg_u32 s3, 0
    s_cbranch_scc1 M_noflag
    v_mov_b32 v64, 0
    buffer_load_dword v64, v64, s[56:59], 0 offen sc1
M_noflag:
    v_perm_b32 v36, v26, v26, v16
    v_perm_b32 v37, v26, v26, v17
    v_perm_b32 v38, v26, v26, v18
    v_perm_b32 v39, v26, v26, v19
    s_waitcnt vmcnt(8)
    buffer_load_dwordx4 v[236:239], v4, s[28:31], s72 offen offset:2048 nt
    s_waitcnt vmcnt(8)
    buffer_load_dwordx4 v[240:243], v4, s[28:31], s72 offen offset:3072 nt
    s_waitcnt vmcnt(8)
    v_mfma_f32_16x16x32_bf16 v[40:43], v[36:39], v[208:211], v[40:43]
    v_perm_b32 v32, v27, v27, v12
    v_perm_b32 v33, v27, v27, v13
    v_perm_b32 v34, v27, v27, v14
    v_perm_b32 v35, v27, v27, v15
    s_waitcnt vmcnt(7)
    buffer_load_dwordx4 v[244:247], v4, s[28:31], s73 offen offset:0 nt
    s_waitcnt vmcnt(7)
    buffer_load_dwordx4 v[248:251], v4, s[28:31], s73 offen offset:1024 nt
    s_waitcnt vmcnt(7)
    v_mfma_f32_16x16x32_bf16 v[40:43], v[32:35], v[220:223], v[40:43]
    v_perm_b32 v36, v27, v27, v16
    v_perm_b32 v37, v27, v27, v17
    v_perm_b32 v38, v27, v27, v18
    v_perm_b32 v39, v27, v27, v19
    s_waitcnt vmcnt(6)
    buffer_load_dwordx4 v[84:87], v4, s[28:31], s73 offen offset:2048 nt
    s_waitcnt vmcnt(6)
    buffer_load_dwordx4 v[88:91], v4, s[28:31], s73 offen offset:3072 nt
    buffer_load_dwordx4 v[92:95], v4, s[32:35], s66 offen offset:0 nt
    buffer_load_dwordx4 v[96:99], v4, s[32:35], s66 offen offset:1024 nt
    s_waitcnt vmcnt(8)
    v_mfma_f32_16x16x32_bf16 v[40:43], v[36:39], v[232:235], v[40:43]
    buffer_load_dwordx4 v[100:103], v4, s[32:35], s66 offen offset:2048 nt
    buffer_load_dwordx4 v[112:115], v4, s[32:35], s66 offen offset:3072 nt
    buffer_load_dwordx4 v[124:127], v4, s[32:35], s67 offen offset:0 nt
    buffer_load_dwordx4 v[136:139], v4, s[32:35], s67 offen offset:1024 nt
    s_mov_b32 exec_hi, 0
    s_nop 2
    ds_write_b128 v60, v[40:43] offset:0
    s_mov_b32 exec_hi, -1
    v_lshlrev_b32 v44, 4, v2
    s_waitcnt lgkmcnt(0)
    s_cmp_lg_u32 s3, 0
    s_cbranch_scc1 M_norace
    s_lshl_b32 s4, s64, 13
    s_xor_b32 s4, s4, s79
    s_mov_b32 s83, 0
    s_mov_b32 s5, 0x5bd1e995
    s_mov_b32 s27, 0
    s_mov_b32 s26, s5
    s_load_dword s26, s[24:25], s4 offset:0
M_race0:
    ds_read_b32 v46, v44
    s_add_u32 s83, s83, 1
    s_cmp_ge_u32 s83, 100
    s_cbranch_scc1 M_raced0
    s_waitcnt lgkmcnt(1)
    s_cmp_eq_u32 s26, s5
    s_cbranch_scc1 M_race0
M_raced0:
    s_xor_b32 s4, s4, 0x2000
    s_waitcnt lgkmcnt(0)
    s_mov_b32 s26, s5
    s_load_dword s26, s[24:25], s4 offset:256
M_race1:
    ds_read_b32 v46, v44
    s_add_u32 s27, s27, 1
    s_cmp_ge_u32 s27, 100
    s_cbranch_scc1 M_raced1
    s_waitcnt lgkmcnt(1)
    s_cmp_eq_u32 s26, s5
    s_cbranch_scc1 M_race1
M_raced1:
    s_xor_b32 s4, s4, 0x2000
    s_waitcnt lgkmcnt(0)
    s_cmp_gt_u32 s83, s27
    s_addc_u32 s83, s64, 0
    s_lshl_b32 s83, s83, 31
M_norace:
    s_barrier
    ds_read2_b32 v[46:47], v61 offset0:0 offset1:132
    s_waitcnt lgkmcnt(0)
    v_add_f32 v46, v46, v47
    s_nop 1
    v_add_f32_dpp v46, v46, v46 quad_perm:[1,0,3,2] row_mask:0xf bank_mask:0xf
    s_nop 1
    v_add_f32_dpp v46, v46, v46 quad_perm:[2,3,0,1] row_mask:0xf bank_mask:0xf
    v_cvt_pk_bf16_f32 v46, v46, v46
    ds_write_b16 v62, v46 offset:4352
    s_waitcnt lgkmcnt(0)
    s_barrier
    ds_read_b128 v[28:31], v44 offset:4352
    s_waitcnt vmcnt(11)
    s_waitcnt vmcnt(10)
    s_waitcnt vmcnt(9)
    s_waitcnt vmcnt(8)
    s_waitcnt vmcnt(7)
    buffer_load_dwordx4 v[148:151], v4, s[32:35], s67 offen offset:2048 nt
    s_waitcnt lgkmcnt(0)
    v_dot2_f32_bf16 v44, v68, v28, 0
    v_dot2_f32_bf16 v45, v72, v28, 0
    v_dot2_f32_bf16 v46, v76, v28, 0
    v_dot2_f32_bf16 v47, v80, v28, 0
    v_dot2_f32_bf16 v44, v69, v29, v44
    v_dot2_f32_bf16 v45, v73, v29, v45
    v_dot2_f32_bf16 v46, v77, v29, v46
    v_dot2_f32_bf16 v47, v81, v29, v47
    v_dot2_f32_bf16 v44, v70, v30, v44
    v_dot2_f32_bf16 v45, v74, v30, v45
    v_dot2_f32_bf16 v46, v78, v30, v46
    v_dot2_f32_bf16 v47, v82, v30, v47
    v_dot2_f32_bf16 v44, v71, v31, v44
    v_dot2_f32_bf16 v45, v75, v31, v45
    v_dot2_f32_bf16 v46, v79, v31, v46
    v_dot2_f32_bf16 v47, v83, v31, v47
    v_add_f32_dpp v44, v44, v44 row_ror:8 row_mask:0xf bank_mask:0x3
    s_nop 0
    v_add_f32_dpp v46, v46, v46 row_ror:8 row_mask:0xf bank_mask:0x3
    v_add_f32_dpp v44, v45, v45 row_ror:8 row_mask:0xf bank_mask:0xc
    s_nop 0
    v_add_f32_dpp v46, v47, v47 row_ror:8 row_mask:0xf bank_mask:0xc
    v_add_f32_dpp v52, v44, v44 row_half_mirror row_mask:0xf bank_mask:0x5
    s_nop 1
    v_add_f32_dpp v52, v46, v46 row_half_mirror row_mask:0xf bank_mask:0xa
    s_nop 1
    v_add_f32_dpp v52, v52, v52 quad_perm:[1,0,3,2] row_mask:0xf bank_mask:0xf
    s_nop 1
    v_add_f32_dpp v52, v52, v52 quad_perm:[2,3,0,1] row_mask:0xf bank_mask:0xf
    v_dot2_f32_bf16 v48, v104, v28, 0
    v_dot2_f32_bf16 v49, v108, v28, 0
    v_dot2_f32_bf16 v50, v116, v28, 0
    v_dot2_f32_bf16 v51, v120, v28, 0
    v_dot2_f32_bf16 v48, v105, v29, v48
    v_dot2_f32_bf16 v49, v109, v29, v49
    v_dot2_f32_bf16 v50, v117, v29, v50
    v_dot2_f32_bf16 v51, v121, v29, v51
    v_dot2_f32_bf16 v48, v106, v30, v48
    v_dot2_f32_bf16 v49, v110, v30, v49
    v_dot2_f32_bf16 v50, v118, v30, v50
    v_dot2_f32_bf16 v51, v122, v30, v51
    v_dot2_f32_bf16 v48, v107, v31, v48
    v_dot2_f32_bf16 v49, v111, v31, v49
    v_dot2_f32_bf16 v50, v119, v31, v50
    v_dot2_f32_bf16 v51, v123, v31, v51
    v_add_f32_dpp v48, v48, v48 row_ror:8 row_mask:0xf bank_mask:0x3
    s_nop 0
    v_add_f32_dpp v50, v50, v50 row_ror:8 row_mask:0xf bank_mask:0x3
    v_add_f32_dpp v48, v49, v49 row_ror:8 row_mask:0xf bank_mask:0xc
    s_nop 0
    v_add_f32_dpp v50, v51, v51 row_ror:8 row_mask:0xf bank_mask:0xc
    v_add_f32_dpp v53, v48, v48 row_half_mirror row_mask:0xf bank_mask:0x5
    s_nop 1
    v_add_f32_dpp v53, v50, v50 row_half_mirror row_mask:0xf bank_mask:0xa
    s_nop 1
    v_add_f32_dpp v53, v53, v53 quad_perm:[1,0,3,2] row_mask:0xf bank_mask:0xf
    s_nop 1
    v_add_f32_dpp v53, v53, v53 quad_perm:[2,3,0,1] row_mask:0xf bank_mask:0xf
    v_dot2_f32_bf16 v44, v128, v28, 0
    v_dot2_f32_bf16 v45, v132, v28, 0
    v_dot2_f32_bf16 v46, v140, v28, 0
    v_dot2_f32_bf16 v47, v144, v28, 0
    v_dot2_f32_bf16 v44, v129, v29, v44
    v_dot2_f32_bf16 v45, v133, v29, v45
    v_dot2_f32_bf16 v46, v141, v29, v46
    v_dot2_f32_bf16 v47, v145, v29, v47
    v_dot2_f32_bf16 v44, v130, v30, v44
    v_dot2_f32_bf16 v45, v134, v30, v45
    v_dot2_f32_bf16 v46, v142, v30, v46
    v_dot2_f32_bf16 v47, v146, v30, v47
    v_dot2_f32_bf16 v44, v131, v31, v44
    v_dot2_f32_bf16 v45, v135, v31, v45
    v_dot2_f32_bf16 v46, v143, v31, v46
    v_dot2_f32_bf16 v47, v147, v31, v47
    v_add_f32_dpp v44, v44, v44 row_ror:8 row_mask:0xf bank_mask:0x3
    s_nop 0
    v_add_f32_dpp v46, v46, v46 row_ror:8 row_mask:0xf bank_mask:0x3
    v_add_f32_dpp v44, v45, v45 row_ror:8 row_mask:0xf bank_mask:0xc
    s_nop 0
    v_add_f32_dpp v46, v47, v47 row_ror:8 row_mask:0xf bank_mask:0xc
    v_add_f32_dpp v54, v44, v44 row_half_mirror row_mask:0xf bank_mask:0x5
    s_nop 1
    v_add_f32_dpp v54, v46, v46 row_half_mirror row_mask:0xf bank_mask:0xa
    s_nop 1
    v_add_f32_dpp v54, v54, v54 quad_perm:[1,0,3,2] row_mask:0xf bank_mask:0xf
    s_nop 1
    v_add_f32_dpp v54, v54, v54 quad_perm:[2,3,0,1] row_mask:0xf bank_mask:0xf
    v_dot2_f32_bf16 v48, v152, v28, 0
    v_dot2_f32_bf16 v49, v156, v28, 0
    v_dot2_f32_bf16 v50, v164, v28, 0
    v_dot2_f32_bf16 v51, v168, v28, 0
    v_dot2_f32_bf16 v48, v153, v29, v48
    v_dot2_f32_bf16 v49, v157, v29, v49
    v_dot2_f32_bf16 v50, v165, v29, v50
    v_dot2_f32_bf16 v51, v169, v29, v51
    v_dot2_f32_bf16 v48, v154, v30, v48
    v_dot2_f32_bf16 v49, v158, v30, v49
    v_dot2_f32_bf16 v50, v166, v30, v50
    v_dot2_f32_bf16 v51, v170, v30, v51
    v_dot2_f32_bf16 v48, v155, v31, v48
    v_dot2_f32_bf16 v49, v159, v31, v49
    v_dot2_f32_bf16 v50, v167, v31, v50
    v_dot2_f32_bf16 v51, v171, v31, v51
    v_add_f32_dpp v48, v48, v48 row_ror:8 row_mask:0xf bank_mask:0x3
    s_nop 0
    v_add_f32_dpp v50, v50, v50 row_ror:8 row_mask:0xf bank_mask:0x3
    v_add_f32_dpp v48, v49, v49 row_ror:8 row_mask:0xf bank_mask:0xc
    s_nop 0
    v_add_f32_dpp v50, v51, v51 row_ror:8 row_mask:0xf bank_mask:0xc
    v_add_f32_dpp v55, v48, v48 row_half_mirror row_mask:0xf bank_mask:0x5
    s_nop 1
    v_add_f32_dpp v55, v50, v50 row_half_mirror row_mask:0xf bank_mask:0xa
    s_nop 1
    v_add_f32_dpp v55, v55, v55 quad_perm:[1,0,3,2] row_mask:0xf bank_mask:0xf
    s_nop 1
    v_add_f32_dpp v55, v55, v55 quad_perm:[2,3,0,1] row_mask:0xf bank_mask:0xf
    v_dot2_f32_bf16 v44, v176, v28, 0
    v_dot2_f32_bf16 v45, v180, v28, 0
    v_dot2_f32_bf16 v46, v188, v28, 0
    v_dot2_f32_bf16 v47, v192, v28, 0
    v_dot2_f32_bf16 v44, v177, v29, v44
    v_dot2_f32_bf16 v45, v181, v29, v45
    v_dot2_f32_bf16 v46, v189, v29, v46
    v_dot2_f32_bf16 v47, v193, v29, v47
    v_dot2_f32_bf16 v44, v178, v30, v44
    v_dot2_f32_bf16 v45, v182, v30, v45
    v_dot2_f32_bf16 v46, v190, v30, v46
    v_dot2_f32_bf16 v47, v194, v30, v47
    v_dot2_f32_bf16 v44, v179, v31, v44
    v_dot2_f32_bf16 v45, v183, v31, v45
    v_dot2_f32_bf16 v46, v191, v31, v46
    v_dot2_f32_bf16 v47, v195, v31, v47
    v_add_f32_dpp v44, v44, v44 row_ror:8 row_mask:0xf bank_mask:0x3
    s_nop 0
    v_add_f32_dpp v46, v46, v46 row_ror:8 row_mask:0xf bank_mask:0x3
    v_add_f32_dpp v44, v45, v45 row_ror:8 row_mask:0xf bank_mask:0xc
    s_nop 0
    v_add_f32_dpp v46, v47, v47 row_ror:8 row_mask:0xf bank_mask:0xc
    v_add_f32_dpp v56, v44, v44 row_half_mirror row_mask:0xf bank_mask:0x5
    s_nop 1
    v_add_f32_dpp v56, v46, v46 row_half_mirror row_mask:0xf bank_mask:0xa
    s_nop 1
    v_add_f32_dpp v56, v56, v56 quad_perm:[1,0,3,2] row_mask:0xf bank_mask:0xf
    s_nop 1
    v_add_f32_dpp v56, v56, v56 quad_perm:[2,3,0,1] row_mask:0xf bank_mask:0xf
    v_dot2_f32_bf16 v48, v200, v28, 0
    v_dot2_f32_bf16 v49, v204, v28, 0
    v_dot2_f32_bf16 v50, v212, v28, 0
    v_dot2_f32_bf16 v51, v216, v28, 0
    v_dot2_f32_bf16 v48, v201, v29, v48
    v_dot2_f32_bf16 v49, v205, v29, v49
    v_dot2_f32_bf16 v50, v213, v29, v50
    v_dot2_f32_bf16 v51, v217, v29, v51
    v_dot2_f32_bf16 v48, v202, v30, v48
    v_dot2_f32_bf16 v49, v206, v30, v49
    v_dot2_f32_bf16 v50, v214, v30, v50
    v_dot2_f32_bf16 v51, v218, v30, v51
    v_dot2_f32_bf16 v48, v203, v31, v48
    v_dot2_f32_bf16 v49, v207, v31, v49
    v_dot2_f32_bf16 v50, v215, v31, v50
    v_dot2_f32_bf16 v51, v219, v31, v51
    v_add_f32_dpp v48, v48, v48 row_ror:8 row_mask:0xf bank_mask:0x3
    s_nop 0
    v_add_f32_dpp v50, v50, v50 row_ror:8 row_mask:0xf bank_mask:0x3
    v_add_f32_dpp v48, v49, v49 row_ror:8 row_mask:0xf bank_mask:0xc
    s_nop 0
    v_add_f32_dpp v50, v51, v51 row_ror:8 row_mask:0xf bank_mask:0xc
    v_add_f32_dpp v57, v48, v48 row_half_mirror row_mask:0xf bank_mask:0x5
    s_nop 1
    v_add_f32_dpp v57, v50, v50 row_half_mirror row_mask:0xf bank_mask:0xa
    s_nop 1
    v_add_f32_dpp v57, v57, v57 quad_perm:[1,0,3,2] row_mask:0xf bank_mask:0xf
    s_nop 1
    v_add_f32_dpp v57, v57, v57 quad_perm:[2,3,0,1] row_mask:0xf bank_mask:0xf
    v_dot2_f32_bf16 v44, v224, v28, 0
    v_dot2_f32_bf16 v45, v228, v28, 0
    v_dot2_f32_bf16 v46, v236, v28, 0
    v_dot2_f32_bf16 v47, v240, v28, 0
    v_dot2_f32_bf16 v44, v225, v29, v44
    v_dot2_f32_bf16 v45, v229, v29, v45
    v_dot2_f32_bf16 v46, v237, v29, v46
    v_dot2_f32_bf16 v47, v241, v29, v47
    v_dot2_f32_bf16 v44, v226, v30, v44
    v_dot2_f32_bf16 v45, v230, v30, v45
    v_dot2_f32_bf16 v46, v238, v30, v46
    v_dot2_f32_bf16 v47, v242, v30, v47
    v_dot2_f32_bf16 v44, v227, v31, v44
    v_dot2_f32_bf16 v45, v231, v31, v45
    v_dot2_f32_bf16 v46, v239, v31, v46
    v_dot2_f32_bf16 v47, v243, v31, v47
    v_add_f32_dpp v44, v44, v44 row_ror:8 row_mask:0xf bank_mask:0x3
    s_nop 0
    v_add_f32_dpp v46, v46, v46 row_ror:8 row_mask:0xf bank_mask:0x3
    v_add_f32_dpp v44, v45, v45 row_ror:8 row_mask:0xf bank_mask:0xc
    s_nop 0
    v_add_f32_dpp v46, v47, v47 row_ror:8 row_mask:0xf bank_mask:0xc
    v_add_f32_dpp v58, v44, v44 row_half_mirror row_mask:0xf bank_mask:0x5
    s_nop 1
    v_add_f32_dpp v58, v46, v46 row_half_mirror row_mask:0xf bank_mask:0xa
    s_nop 1
    v_add_f32_dpp v58, v58, v58 quad_perm:[1,0,3,2] row_mask:0xf bank_mask:0xf
    s_nop 1
    v_add_f32_dpp v58, v58, v58 quad_perm:[2,3,0,1] row_mask:0xf bank_mask:0xf
    s_waitcnt vmcnt(7)
    buffer_load_dwordx4 v[160:163], v4, s[32:35], s67 offen offset:3072 nt
    v_dot2_f32_bf16 v48, v244, v28, 0
    v_dot2_f32_bf16 v49, v248, v28, 0
    v_dot2_f32_bf16 v50, v84, v28, 0
    v_dot2_f32_bf16 v51, v88, v28, 0
    v_dot2_f32_bf16 v48, v245, v29, v48
    v_dot2_f32_bf16 v49, v249, v29, v49
    v_dot2_f32_bf16 v50, v85, v29, v50
    v_dot2_f32_bf16 v51, v89, v29, v51
    v_dot2_f32_bf16 v48, v246, v30, v48
    v_dot2_f32_bf16 v49, v250, v30, v49
    v_dot2_f32_bf16 v50, v86, v30, v50
    v_dot2_f32_bf16 v51, v90, v30, v51
    v_dot2_f32_bf16 v48, v247, v31, v48
    v_dot2_f32_bf16 v49, v251, v31, v49
    v_dot2_f32_bf16 v50, v87, v31, v50
    v_dot2_f32_bf16 v51, v91, v31, v51
    v_add_f32_dpp v48, v48, v48 row_ror:8 row_mask:0xf bank_mask:0x3
    s_nop 0
    v_add_f32_dpp v50, v50, v50 row_ror:8 row_mask:0xf bank_mask:0x3
    v_add_f32_dpp v48, v49, v49 row_ror:8 row_mask:0xf bank_mask:0xc
    s_nop 0
    v_add_f32_dpp v50, v51, v51 row_ror:8 row_mask:0xf bank_mask:0xc
    v_add_f32_dpp v59, v48, v48 row_half_mirror row_mask:0xf bank_mask:0x5
    s_nop 1
    v_add_f32_dpp v59, v50, v50 row_half_mirror row_mask:0xf bank_mask:0xa
    s_nop 1
    v_add_f32_dpp v59, v59, v59 quad_perm:[1,0,3,2] row_mask:0xf bank_mask:0xf
    s_nop 1
    v_add_f32_dpp v59, v59, v59 quad_perm:[2,3,0,1] row_mask:0xf bank_mask:0xf
    buffer_load_dwordx4 v[172:175], v4, s[32:35], s68 offen offset:0 nt
    buffer_load_dwordx4 v[184:187], v4, s[32:35], s68 offen offset:1024 nt
    s_mov_b32 s4, 0xffff0000
    s_mov_b32 s5, 0x3db504f3
    s_mov_b32 s6, 0x3fb8aa3b
    v_cvt_pk_bf16_f32 v52, v52, v52
    v_cvt_pk_bf16_f32 v53, v53, v53
    v_cvt_pk_bf16_f32 v54, v54, v54
    v_cvt_pk_bf16_f32 v55, v55, v55
    v_cvt_pk_bf16_f32 v56, v56, v56
    v_cvt_pk_bf16_f32 v57, v57, v57
    v_cvt_pk_bf16_f32 v58, v58, v58
    v_cvt_pk_bf16_f32 v59, v59, v59
    v_and_b32 v52, s4, v52
    v_and_b32 v53, s4, v53
    v_and_b32 v54, s4, v54
    v_and_b32 v55, s4, v55
    v_and_b32 v56, s4, v56
    v_and_b32 v57, s4, v57
    v_and_b32 v58, s4, v58
    v_and_b32 v59, s4, v59
    v_mul_f32 v52, s5, v52
    v_mul_f32 v53, s5, v53
    v_mul_f32 v54, s5, v54
    v_mul_f32 v55, s5, v55
    v_mul_f32 v56, s5, v56
    v_mul_f32 v57, s5, v57
    v_mul_f32 v58, s5, v58
    v_mul_f32 v59, s5, v59
    v_cvt_pk_bf16_f32 v52, v52, v52
    v_cvt_pk_bf16_f32 v53, v53, v53
    v_cvt_pk_bf16_f32 v54, v54, v54
    v_cvt_pk_bf16_f32 v55, v55, v55
    v_cvt_pk_bf16_f32 v56, v56, v56
    v_cvt_pk_bf16_f32 v57, v57, v57
    v_cvt_pk_bf16_f32 v58, v58, v58
    v_cvt_pk_bf16_f32 v59, v59, v59
    v_and_b32 v52, s4, v52
    v_and_b32 v53, s4, v53
    v_and_b32 v54, s4, v54
    v_and_b32 v55, s4, v55
    v_and_b32 v56, s4, v56
    v_and_b32 v57, s4, v57
    v_and_b32 v58, s4, v58
    v_and_b32 v59, s4, v59
    v_max3_f32 v44, v52, v53, v54
    v_max3_f32 v45, v55, v56, v57
    v_max3_f32 v44, v44, v58, v59
    v_max_f32 v44, v44, v45
    s_nop 1
    v_max_f32_dpp v44, v44, v44 row_ror:4 row_mask:0xf bank_mask:0xf
    s_nop 1
    v_max_f32_dpp v44, v44, v44 row_ror:8 row_mask:0xf bank_mask:0xf
    v_mov_b32 v45, v44
    s_nop 1
    v_permlane16_swap_b32 v44, v45
    v_max_f32 v44, v44, v45
    v_mov_b32 v45, v44
    s_nop 1
    v_permlane32_swap_b32 v44, v45
    v_max_f32 v44, v44, v45
    v_sub_f32 v52, v52, v44
    v_sub_f32 v53, v53, v44
    v_sub_f32 v54, v54, v44
    v_sub_f32 v55, v55, v44
    v_sub_f32 v56, v56, v44
    v_sub_f32 v57, v57, v44
    v_sub_f32 v58, v58, v44
    v_sub_f32 v59, v59, v44
    v_mul_f32 v52, s6, v52
    v_mul_f32 v53, s6, v53
    v_mul_f32 v54, s6, v54
    v_mul_f32 v55, s6, v55
    v_mul_f32 v56, s6, v56
    v_mul_f32 v57, s6, v57
    v_mul_f32 v58, s6, v58
    v_mul_f32 v59, s6, v59
    v_exp_f32 v52, v52
    v_exp_f32 v53, v53
    v_exp_f32 v54, v54
    v_exp_f32 v55, v55
    v_exp_f32 v56, v56
    v_exp_f32 v57, v57
    v_exp_f32 v58, v58
    v_exp_f32 v59, v59
    v_add_f32 v45, v52, v53
    v_add_f32 v46, v54, v55
    v_add_f32 v47, v56, v57
    v_add_f32 v48, v58, v59
    v_add_f32 v45, v45, v46
    v_add_f32 v47, v47, v48
    v_add_f32 v45, v45, v47
    s_nop 1
    v_add_f32_dpp v45, v45, v45 row_ror:4 row_mask:0xf bank_mask:0xf
    s_nop 1
    v_add_f32_dpp v45, v45, v45 row_ror:8 row_mask:0xf bank_mask:0xf
    v_mov_b32 v46, v45
    s_nop 1
    v_permlane16_swap_b32 v45, v46
    v_add_f32 v45, v45, v46
    v_mov_b32 v46, v45
    s_nop 1
    v_permlane32_swap_b32 v45, v46
    v_add_f32 v45, v45, v46
    s_lshl_b32 s5, s3, 3
    v_mov_b32 v46, s5
    ds_write_b64 v46, v[44:45] offset:4608
    v_bfe_u32 v13, v0, 2, 3
    v_lshlrev_b32 v12, 7, v13
    v_lshrrev_b32 v13, 1, v13
    v_lshl_add_u32 v12, v13, 5, v12
    v_and_b32 v13, 3, v0
    v_lshl_add_u32 v12, v13, 3, v12
    v_bfe_u32 v13, v0, 5, 1
    v_lshl_add_u32 v12, v13, 11, v12
    v_add_u32 v12, s19, v12
    v_xor_b32 v13, 32, v12
    v_xor_b32 v14, 64, v12
    v_xor_b32 v15, 96, v12
    v_lshrrev_b32 v16, 1, v2
    v_lshlrev_b32 v16, 5, v16
    v_bfe_u32 v17, v0, 4, 1
    v_lshl_add_u32 v16, v17, 3, v16
    v_and_b32 v17, 1, v0
    v_lshl_add_u32 v16, v17, 2, v16
    s_mul_i32 s5, s3, 320
    s_add_u32 s5, s5, 1024
    v_add_u32 v16, s5, v16
    v_and_b32 v46, 7, v0
    v_mul_u32_u24 v17, 320, v46
    v_lshl_add_u32 v17, v3, 5, v17
    v_bfe_u32 v19, v0, 3, 1
    v_lshl_add_u32 v17, v19, 4, v17
    v_mul_u32_u24 v19, 0xaaaa, v19
    v_add_u32 v19, 0x4444, v19
    v_lshlrev_b32 v46, 3, v46
    s_waitcnt lgkmcnt(0)
    s_barrier
    ds_read_b64 v[46:47], v46 offset:4608
    s_waitcnt vmcnt(9)
    s_waitcnt vmcnt(8)
    s_waitcnt vmcnt(7)
    buffer_load_dwordx4 v[196:199], v4, s[32:35], s68 offen offset:2048 nt
    v_mov_b32 v50, 0
    s_waitcnt lgkmcnt(0)
    v_mov_b32 v48, v46
    s_nop 1
    v_max_f32_dpp v48, v48, v48 quad_perm:[1,0,3,2] row_mask:0xf bank_mask:0xf
    s_nop 1
    v_max_f32_dpp v48, v48, v48 quad_perm:[2,3,0,1] row_mask:0xf bank_mask:0xf
    s_nop 1
    v_max_f32_dpp v48, v48, v48 row_half_mirror row_mask:0xf bank_mask:0xf
    v_sub_f32 v46, v46, v48
    v_sub_f32 v44, v44, v48
    v_mul_f32 v46, s6, v46
    v_mul_f32 v44, s6, v44
    v_exp_f32 v46, v46
    v_exp_f32 v44, v44
    v_mul_f32 v49, v46, v47
    v_mul_f32 v52, v44, v52
    v_mul_f32 v53, v44, v53
    v_mul_f32 v54, v44, v54
    v_mul_f32 v55, v44, v55
    v_mul_f32 v56, v44, v56
    v_mul_f32 v57, v44, v57
    v_mul_f32 v58, v44, v58
    v_mul_f32 v59, v44, v59
    v_cvt_pk_bf16_f32 v52, v52, v52
    v_cvt_pk_bf16_f32 v53, v53, v53
    v_cvt_pk_bf16_f32 v54, v54, v54
    v_cvt_pk_bf16_f32 v55, v55, v55
    v_cvt_pk_bf16_f32 v56, v56, v56
    v_cvt_pk_bf16_f32 v57, v57, v57
    v_cvt_pk_bf16_f32 v58, v58, v58
    v_cvt_pk_bf16_f32 v59, v59, v59
    s_cmp_lg_u32 s3, 0
    s_cbranch_scc1 M_noml
    v_add_f32_dpp v49, v49, v49 quad_perm:[1,0,3,2] row_mask:0xf bank_mask:0xf
    s_nop 1
    v_add_f32_dpp v49, v49, v49 quad_perm:[2,3,0,1] row_mask:0xf bank_mask:0xf
    s_nop 1
    v_add_f32_dpp v49, v49, v49 row_half_mirror row_mask:0xf bank_mask:0xf
    s_mov_b32 s5, 0
M_flag:
    v_readfirstlane_b32 s4, v64
    s_add_u32 s5, s5, 1
    s_nop 0
    s_cmp_eq_u32 s4, 1
    s_cbranch_scc1 M_flag_ok
    s_cmp_ge_u32 s5, 65536
    s_cbranch_scc1 M_flag_ok
    buffer_load_dword v64, v50, s[56:59], 0 offen sc1
    s_waitcnt vmcnt(0)
    s_branch M_flag
M_flag_ok:
    v_or_b32 v49, s83, v49
    v_min_u32 v48, -2, v48
    v_min_u32 v49, -2, v49
    s_mov_b64 exec, 1
    buffer_store_dwordx2 v[48:49], v50, s[48:51], s80 offen sc1
    s_mov_b64 exec, -1
M_noml:
    s_lshl_b32 s6, s7, 9
    s_add_u32 s6, s6, 1048576
    v_lshlrev_b32 v45, 3, v1
    s_xor_b32 s27, s6, 1024
    v_and_b32_dpp v32, v52, v8 row_newbcast:0 row_mask:0xf bank_mask:0xf
    v_and_b32_dpp v33, v52, v9 row_newbcast:0 row_mask:0xf bank_mask:0xf
    v_and_b32_dpp v34, v52, v10 row_newbcast:0 row_mask:0xf bank_mask:0xf
    v_and_b32_dpp v35, v52, v11 row_newbcast:0 row_mask:0xf bank_mask:0xf
    s_nop 1
    v_mfma_f32_16x16x32_bf16 v[40:43], v[32:35], v[92:95], 0
    v_and_b32_dpp v36, v52, v8 row_newbcast:8 row_mask:0xf bank_mask:0xf
    v_and_b32_dpp v37, v52, v9 row_newbcast:8 row_mask:0xf bank_mask:0xf
    v_and_b32_dpp v38, v52, v10 row_newbcast:8 row_mask:0xf bank_mask:0xf
    v_and_b32_dpp v39, v52, v11 row_newbcast:8 row_mask:0xf bank_mask:0xf
    s_nop 1
    v_mfma_f32_16x16x32_bf16 v[40:43], v[36:39], v[96:99], v[40:43]
    v_and_b32_dpp v32, v52, v8 row_newbcast:4 row_mask:0xf bank_mask:0xf
    v_and_b32_dpp v33, v52, v9 row_newbcast:4 row_mask:0xf bank_mask:0xf
    v_and_b32_dpp v34, v52, v10 row_newbcast:4 row_mask:0xf bank_mask:0xf
    v_and_b32_dpp v35, v52, v11 row_newbcast:4 row_mask:0xf bank_mask:0xf
    s_nop 1
    v_mfma_f32_16x16x32_bf16 v[40:43], v[32:35], v[100:103], v[40:43]
    v_and_b32_dpp v36, v52, v8 row_newbcast:12 row_mask:0xf bank_mask:0xf
    v_and_b32_dpp v37, v52, v9 row_newbcast:12 row_mask:0xf bank_mask:0xf
    v_and_b32_dpp v38, v52, v10 row_newbcast:12 row_mask:0xf bank_mask:0xf
    v_and_b32_dpp v39, v52, v11 row_newbcast:12 row_mask:0xf bank_mask:0xf
    s_waitcnt vmcnt(7)
    buffer_load_dwordx4 v[208:211], v4, s[32:35], s68 offen offset:3072 nt
    v_mfma_f32_16x16x32_bf16 v[40:43], v[36:39], v[112:115], v[40:43]
    v_and_b32_dpp v32, v53, v8 row_newbcast:0 row_mask:0xf bank_mask:0xf
    v_and_b32_dpp v33, v53, v9 row_newbcast:0 row_mask:0xf bank_mask:0xf
    v_and_b32_dpp v34, v53, v10 row_newbcast:0 row_mask:0xf bank_mask:0xf
    v_and_b32_dpp v35, v53, v11 row_newbcast:0 row_mask:0xf bank_mask:0xf
    s_waitcnt vmcnt(7)
    buffer_load_dwordx4 v[220:223], v4, s[32:35], s69 offen offset:0 nt
    v_mfma_f32_16x16x32_bf16 v[40:43], v[32:35], v[124:127], v[40:43]
    v_and_b32_dpp v36, v53, v8 row_newbcast:8 row_mask:0xf bank_mask:0xf
    v_and_b32_dpp v37, v53, v9 row_newbcast:8 row_mask:0xf bank_mask:0xf
    v_and_b32_dpp v38, v53, v10 row_newbcast:8 row_mask:0xf bank_mask:0xf
    v_and_b32_dpp v39, v53, v11 row_newbcast:8 row_mask:0xf bank_mask:0xf
    s_waitcnt vmcnt(7)
    buffer_load_dwordx4 v[232:235], v4, s[32:35], s69 offen offset:1024 nt
    v_mfma_f32_16x16x32_bf16 v[40:43], v[36:39], v[136:139], v[40:43]
    v_and_b32_dpp v32, v53, v8 row_newbcast:4 row_mask:0xf bank_mask:0xf
    v_and_b32_dpp v33, v53, v9 row_newbcast:4 row_mask:0xf bank_mask:0xf
    v_and_b32_dpp v34, v53, v10 row_newbcast:4 row_mask:0xf bank_mask:0xf
    v_and_b32_dpp v35, v53, v11 row_newbcast:4 row_mask:0xf bank_mask:0xf
    s_waitcnt vmcnt(7)
    buffer_load_dwordx4 v[68:71], v4, s[32:35], s69 offen offset:2048 nt
    v_mfma_f32_16x16x32_bf16 v[40:43], v[32:35], v[148:151], v[40:43]
    v_and_b32_dpp v36, v53, v8 row_newbcast:12 row_mask:0xf bank_mask:0xf
    v_and_b32_dpp v37, v53, v9 row_newbcast:12 row_mask:0xf bank_mask:0xf
    v_and_b32_dpp v38, v53, v10 row_newbcast:12 row_mask:0xf bank_mask:0xf
    v_and_b32_dpp v39, v53, v11 row_newbcast:12 row_mask:0xf bank_mask:0xf
    s_waitcnt vmcnt(7)
    buffer_load_dwordx4 v[72:75], v4, s[32:35], s69 offen offset:3072 nt
    v_mfma_f32_16x16x32_bf16 v[40:43], v[36:39], v[160:163], v[40:43]
    v_and_b32_dpp v32, v54, v8 row_newbcast:0 row_mask:0xf bank_mask:0xf
    v_and_b32_dpp v33, v54, v9 row_newbcast:0 row_mask:0xf bank_mask:0xf
    v_and_b32_dpp v34, v54, v10 row_newbcast:0 row_mask:0xf bank_mask:0xf
    v_and_b32_dpp v35, v54, v11 row_newbcast:0 row_mask:0xf bank_mask:0xf
    s_waitcnt vmcnt(7)
    buffer_load_dwordx4 v[76:79], v4, s[32:35], s70 offen offset:0 nt
    v_mfma_f32_16x16x32_bf16 v[40:43], v[32:35], v[172:175], v[40:43]
    v_and_b32_dpp v36, v54, v8 row_newbcast:8 row_mask:0xf bank_mask:0xf
    v_and_b32_dpp v37, v54, v9 row_newbcast:8 row_mask:0xf bank_mask:0xf
    v_and_b32_dpp v38, v54, v10 row_newbcast:8 row_mask:0xf bank_mask:0xf
    v_and_b32_dpp v39, v54, v11 row_newbcast:8 row_mask:0xf bank_mask:0xf
    s_waitcnt vmcnt(7)
    buffer_load_dwordx4 v[80:83], v4, s[32:35], s70 offen offset:1024 nt
    s_barrier
    s_add_u32 m0, s19, s74
    s_lshl_b32 s81, s74, 3
    buffer_load_dwordx4 v6, s[40:43], s81 offen offset:0 lds
    s_add_u32 s81, s81, 7168
    buffer_load_dwordx4 v6, s[40:43], s81 offen offset:1024 lds
    s_add_u32 s81, s81, 7168
    buffer_load_dwordx4 v6, s[40:43], s81 offen offset:2048 lds
    s_add_u32 s81, s81, 7168
    buffer_load_dwordx4 v6, s[40:43], s81 offen offset:3072 lds
    s_add_u32 m0, s19, s75
    s_lshl_b32 s81, s75, 3
    buffer_load_dwordx4 v6, s[40:43], s81 offen offset:0 lds
    s_add_u32 s81, s81, 7168
    buffer_load_dwordx4 v6, s[40:43], s81 offen offset:1024 lds
    s_add_u32 s81, s81, 7168
    buffer_load_dwordx4 v6, s[40:43], s81 offen offset:2048 lds
    s_add_u32 s81, s81, 7168
    buffer_load_dwordx4 v6, s[40:43], s81 offen offset:3072 lds
    s_add_u32 m0, s19, s76
    s_lshl_b32 s81, s76, 3
    buffer_load_dwordx4 v6, s[40:43], s81 offen offset:0 lds
    s_add_u32 s81, s81, 7168
    buffer_load_dwordx4 v6, s[40:43], s81 offen offset:1024 lds
    s_add_u32 s81, s81, 7168
    buffer_load_dwordx4 v6, s[40:43], s81 offen offset:2048 lds
    s_add_u32 s81, s81, 7168
    buffer_load_dwordx4 v6, s[40:43], s81 offen offset:3072 lds
    s_add_u32 m0, s19, s77
    s_lshl_b32 s81, s77, 3
    buffer_load_dwordx4 v6, s[40:43], s81 offen offset:0 lds
    s_add_u32 s81, s81, 7168
    buffer_load_dwordx4 v6, s[40:43], s81 offen offset:1024 lds
    s_add_u32 s81, s81, 7168
    buffer_load_dwordx4 v6, s[40:43], s81 offen offset:2048 lds
    s_add_u32 s81, s81, 7168
    buffer_load_dwordx4 v6, s[40:43], s81 offen offset:3072 lds
    v_mfma_f32_16x16x32_bf16 v[40:43], v[36:39], v[184:187], v[40:43]
    v_and_b32_dpp v32, v54, v8 row_newbcast:4 row_mask:0xf bank_mask:0xf
    v_and_b32_dpp v33, v54, v9 row_newbcast:4 row_mask:0xf bank_mask:0xf
    v_and_b32_dpp v34, v54, v10 row_newbcast:4 row_mask:0xf bank_mask:0xf
    v_and_b32_dpp v35, v54, v11 row_newbcast:4 row_mask:0xf bank_mask:0xf
    s_waitcnt vmcnt(23)
    buffer_load_dwordx4 v[104:107], v4, s[32:35], s70 offen offset:2048 nt
    v_mfma_f32_16x16x32_bf16 v[40:43], v[32:35], v[196:199], v[40:43]
    v_and_b32_dpp v36, v54, v8 row_newbcast:12 row_mask:0xf bank_mask:0xf
    v_and_b32_dpp v37, v54, v9 row_newbcast:12 row_mask:0xf bank_mask:0xf
    v_and_b32_dpp v38, v54, v10 row_newbcast:12 row_mask:0xf bank_mask:0xf
    v_and_b32_dpp v39, v54, v11 row_newbcast:12 row_mask:0xf bank_mask:0xf
    s_waitcnt vmcnt(23)
    buffer_load_dwordx4 v[108:111], v4, s[32:35], s70 offen offset:3072 nt
    v_mfma_f32_16x16x32_bf16 v[40:43], v[36:39], v[208:211], v[40:43]
    v_and_b32_dpp v32, v55, v8 row_newbcast:0 row_mask:0xf bank_mask:0xf
    v_and_b32_dpp v33, v55, v9 row_newbcast:0 row_mask:0xf bank_mask:0xf
    v_and_b32_dpp v34, v55, v10 row_newbcast:0 row_mask:0xf bank_mask:0xf
    v_and_b32_dpp v35, v55, v11 row_newbcast:0 row_mask:0xf bank_mask:0xf
    s_waitcnt vmcnt(23)
    buffer_load_dwordx4 v[116:119], v4, s[32:35], s71 offen offset:0 nt
    v_mfma_f32_16x16x32_bf16 v[40:43], v[32:35], v[220:223], v[40:43]
    v_and_b32_dpp v36, v55, v8 row_newbcast:8 row_mask:0xf bank_mask:0xf
    v_and_b32_dpp v37, v55, v9 row_newbcast:8 row_mask:0xf bank_mask:0xf
    v_and_b32_dpp v38, v55, v10 row_newbcast:8 row_mask:0xf bank_mask:0xf
    v_and_b32_dpp v39, v55, v11 row_newbcast:8 row_mask:0xf bank_mask:0xf
    s_waitcnt vmcnt(23)
    buffer_load_dwordx4 v[120:123], v4, s[32:35], s71 offen offset:1024 nt
    v_mfma_f32_16x16x32_bf16 v[40:43], v[36:39], v[232:235], v[40:43]
    v_and_b32_dpp v32, v55, v8 row_newbcast:4 row_mask:0xf bank_mask:0xf
    v_and_b32_dpp v33, v55, v9 row_newbcast:4 row_mask:0xf bank_mask:0xf
    v_and_b32_dpp v34, v55, v10 row_newbcast:4 row_mask:0xf bank_mask:0xf
    v_and_b32_dpp v35, v55, v11 row_newbcast:4 row_mask:0xf bank_mask:0xf
    s_waitcnt vmcnt(23)
    buffer_load_dwordx4 v[128:131], v4, s[32:35], s71 offen offset:2048 nt
    v_mfma_f32_16x16x32_bf16 v[40:43], v[32:35], v[68:71], v[40:43]
    v_and_b32_dpp v36, v55, v8 row_newbcast:12 row_mask:0xf bank_mask:0xf
    v_and_b32_dpp v37, v55, v9 row_newbcast:12 row_mask:0xf bank_mask:0xf
    v_and_b32_dpp v38, v55, v10 row_newbcast:12 row_mask:0xf bank_mask:0xf
    v_and_b32_dpp v39, v55, v11 row_newbcast:12 row_mask:0xf bank_mask:0xf
    s_waitcnt vmcnt(23)
    buffer_load_dwordx4 v[132:135], v4, s[32:35], s71 offen offset:3072 nt
    v_mfma_f32_16x16x32_bf16 v[40:43], v[36:39], v[72:75], v[40:43]
    v_and_b32_dpp v32, v56, v8 row_newbcast:0 row_mask:0xf bank_mask:0xf
    v_and_b32_dpp v33, v56, v9 row_newbcast:0 row_mask:0xf bank_mask:0xf
    v_and_b32_dpp v34, v56, v10 row_newbcast:0 row_mask:0xf bank_mask:0xf
    v_and_b32_dpp v35, v56, v11 row_newbcast:0 row_mask:0xf bank_mask:0xf
    s_waitcnt vmcnt(23)
    buffer_load_dwordx4 v[140:143], v4, s[32:35], s72 offen offset:0 nt
    v_mfma_f32_16x16x32_bf16 v[40:43], v[32:35], v[76:79], v[40:43]
    v_and_b32_dpp v36, v56, v8 row_newbcast:8 row_mask:0xf bank_mask:0xf
    v_and_b32_dpp v37, v56, v9 row_newbcast:8 row_mask:0xf bank_mask:0xf
    v_and_b32_dpp v38, v56, v10 row_newbcast:8 row_mask:0xf bank_mask:0xf
    v_and_b32_dpp v39, v56, v11 row_newbcast:8 row_mask:0xf bank_mask:0xf
    s_waitcnt vmcnt(23)
    buffer_load_dwordx4 v[144:147], v4, s[32:35], s72 offen offset:1024 nt
    v_mfma_f32_16x16x32_bf16 v[40:43], v[36:39], v[80:83], v[40:43]
    v_and_b32_dpp v32, v56, v8 row_newbcast:4 row_mask:0xf bank_mask:0xf
    v_and_b32_dpp v33, v56, v9 row_newbcast:4 row_mask:0xf bank_mask:0xf
    v_and_b32_dpp v34, v56, v10 row_newbcast:4 row_mask:0xf bank_mask:0xf
    v_and_b32_dpp v35, v56, v11 row_newbcast:4 row_mask:0xf bank_mask:0xf
    s_waitcnt vmcnt(7)
    buffer_load_dwordx4 v[152:155], v4, s[32:35], s72 offen offset:2048 nt
    v_mfma_f32_16x16x32_bf16 v[40:43], v[32:35], v[104:107], v[40:43]
    ds_read_b64_tr_b16 v[80:81], v12 offset:0
    ds_read_b64_tr_b16 v[82:83], v12 offset:1024
    ds_read_b64_tr_b16 v[72:73], v13 offset:0
    ds_read_b64_tr_b16 v[74:75], v13 offset:1024
    ds_read_b64_tr_b16 v[232:233], v14 offset:0
    ds_read_b64_tr_b16 v[234:235], v14 offset:1024
    ds_read_b64_tr_b16 v[220:221], v15 offset:0
    ds_read_b64_tr_b16 v[222:223], v15 offset:1024
    v_and_b32_dpp v36, v56, v8 row_newbcast:12 row_mask:0xf bank_mask:0xf
    v_and_b32_dpp v37, v56, v9 row_newbcast:12 row_mask:0xf bank_mask:0xf
    v_and_b32_dpp v38, v56, v10 row_newbcast:12 row_mask:0xf bank_mask:0xf
    v_and_b32_dpp v39, v56, v11 row_newbcast:12 row_mask:0xf bank_mask:0xf
    s_waitcnt vmcnt(7)
    buffer_load_dwordx4 v[156:159], v4, s[32:35], s72 offen offset:3072 nt
    v_mfma_f32_16x16x32_bf16 v[40:43], v[36:39], v[108:111], v[40:43]
    ds_read_b64_tr_b16 v[84:85], v12 offset:4096
    ds_read_b64_tr_b16 v[86:87], v12 offset:5120
    ds_read_b64_tr_b16 v[76:77], v13 offset:4096
    ds_read_b64_tr_b16 v[78:79], v13 offset:5120
    ds_read_b64_tr_b16 v[236:237], v14 offset:4096
    ds_read_b64_tr_b16 v[238:239], v14 offset:5120
    ds_read_b64_tr_b16 v[224:225], v15 offset:4096
    ds_read_b64_tr_b16 v[226:227], v15 offset:5120
    v_and_b32_dpp v32, v57, v8 row_newbcast:0 row_mask:0xf bank_mask:0xf
    v_and_b32_dpp v33, v57, v9 row_newbcast:0 row_mask:0xf bank_mask:0xf
    v_and_b32_dpp v34, v57, v10 row_newbcast:0 row_mask:0xf bank_mask:0xf
    v_and_b32_dpp v35, v57, v11 row_newbcast:0 row_mask:0xf bank_mask:0xf
    s_waitcnt vmcnt(7)
    buffer_load_dwordx4 v[164:167], v4, s[32:35], s73 offen offset:0 nt
    v_mfma_f32_16x16x32_bf16 v[40:43], v[32:35], v[116:119], v[40:43]
    ds_read_b64_tr_b16 v[108:109], v12 offset:8192
    ds_read_b64_tr_b16 v[110:111], v12 offset:9216
    ds_read_b64_tr_b16 v[208:209], v13 offset:8192
    ds_read_b64_tr_b16 v[210:211], v13 offset:9216
    ds_read_b64_tr_b16 v[196:197], v14 offset:8192
    ds_read_b64_tr_b16 v[198:199], v14 offset:9216
    ds_read_b64_tr_b16 v[184:185], v15 offset:8192
    ds_read_b64_tr_b16 v[186:187], v15 offset:9216
    s_cmp_lg_u32 s3, 0
    s_cbranch_scc1 M_nomlpre
    buffer_load_dwordx2 v[48:49], v45, s[48:51], s6 offen sc1
    buffer_load_dwordx2 v[20:21], v45, s[48:51], s27 offen sc1
    v_mov_b32 v47, 1
    s_lshl_b32 s4, s7, 6
    s_mov_b64 exec, 1
    buffer_atomic_add v47, v50, s[56:59], s4 offen offset:32 sc0 sc1
    s_mov_b64 exec, -1
M_nomlpre:
    s_nop 1
    v_and_b32_dpp v36, v57, v8 row_newbcast:8 row_mask:0xf bank_mask:0xf
    v_and_b32_dpp v37, v57, v9 row_newbcast:8 row_mask:0xf bank_mask:0xf
    v_and_b32_dpp v38, v57, v10 row_newbcast:8 row_mask:0xf bank_mask:0xf
    v_and_b32_dpp v39, v57, v11 row_newbcast:8 row_mask:0xf bank_mask:0xf
    s_waitcnt vmcnt(7)
    buffer_load_dwordx4 v[168:171], v4, s[32:35], s73 offen offset:1024 nt
    v_mfma_f32_16x16x32_bf16 v[40:43], v[36:39], v[120:123], v[40:43]
    v_mov_b32 v120, 0
    v_mov_b32 v121, 0
    v_mov_b32 v122, 0
    v_mov_b32 v123, 0
    ds_read_b64_tr_b16 v[112:113], v12 offset:12288
    ds_read_b64_tr_b16 v[114:115], v12 offset:13312
    v_mov_b32 v116, 0
    v_mov_b32 v117, 0
    v_mov_b32 v118, 0
    v_mov_b32 v119, 0
    ds_read_b64_tr_b16 v[212:213], v13 offset:12288
    ds_read_b64_tr_b16 v[214:215], v13 offset:13312
    v_mov_b32 v104, 0
    v_mov_b32 v105, 0
    v_mov_b32 v106, 0
    v_mov_b32 v107, 0
    ds_read_b64_tr_b16 v[200:201], v14 offset:12288
    ds_read_b64_tr_b16 v[202:203], v14 offset:13312
    v_mov_b32 v68, 0
    v_mov_b32 v69, 0
    v_mov_b32 v70, 0
    v_mov_b32 v71, 0
    ds_read_b64_tr_b16 v[188:189], v15 offset:12288
    ds_read_b64_tr_b16 v[190:191], v15 offset:13312
    v_and_b32_dpp v32, v57, v8 row_newbcast:4 row_mask:0xf bank_mask:0xf
    v_and_b32_dpp v33, v57, v9 row_newbcast:4 row_mask:0xf bank_mask:0xf
    v_and_b32_dpp v34, v57, v10 row_newbcast:4 row_mask:0xf bank_mask:0xf
    v_and_b32_dpp v35, v57, v11 row_newbcast:4 row_mask:0xf bank_mask:0xf
    s_waitcnt vmcnt(7)
    buffer_load_dwordx4 v[176:179], v4, s[32:35], s73 offen offset:2048 nt
    v_mfma_f32_16x16x32_bf16 v[40:43], v[32:35], v[128:131], v[40:43]
    v_and_b32_dpp v36, v57, v8 row_newbcast:12 row_mask:0xf bank_mask:0xf
    v_and_b32_dpp v37, v57, v9 row_newbcast:12 row_mask:0xf bank_mask:0xf
    v_and_b32_dpp v38, v57, v10 row_newbcast:12 row_mask:0xf bank_mask:0xf
    v_and_b32_dpp v39, v57, v11 row_newbcast:12 row_mask:0xf bank_mask:0xf
    s_waitcnt vmcnt(7)
    buffer_load_dwordx4 v[180:183], v4, s[32:35], s73 offen offset:3072 nt
    v_mfma_f32_16x16x32_bf16 v[40:43], v[36:39], v[132:135], v[40:43]
    v_and_b32_dpp v32, v58, v8 row_newbcast:0 row_mask:0xf bank_mask:0xf
    v_and_b32_dpp v33, v58, v9 row_newbcast:0 row_mask:0xf bank_mask:0xf
    v_and_b32_dpp v34, v58, v10 row_newbcast:0 row_mask:0xf bank_mask:0xf
    v_and_b32_dpp v35, v58, v11 row_newbcast:0 row_mask:0xf bank_mask:0xf
    s_waitcnt vmcnt(7)
    s_nop 0
    v_mfma_f32_16x16x32_bf16 v[40:43], v[32:35], v[140:143], v[40:43]
    v_and_b32_dpp v36, v58, v8 row_newbcast:8 row_mask:0xf bank_mask:0xf
    v_and_b32_dpp v37, v58, v9 row_newbcast:8 row_mask:0xf bank_mask:0xf
    v_and_b32_dpp v38, v58, v10 row_newbcast:8 row_mask:0xf bank_mask:0xf
    v_and_b32_dpp v39, v58, v11 row_newbcast:8 row_mask:0xf bank_mask:0xf
    s_waitcnt vmcnt(6)
    s_nop 0
    v_mfma_f32_16x16x32_bf16 v[40:43], v[36:39], v[144:147], v[40:43]
    v_and_b32_dpp v32, v58, v8 row_newbcast:4 row_mask:0xf bank_mask:0xf
    v_and_b32_dpp v33, v58, v9 row_newbcast:4 row_mask:0xf bank_mask:0xf
    v_and_b32_dpp v34, v58, v10 row_newbcast:4 row_mask:0xf bank_mask:0xf
    v_and_b32_dpp v35, v58, v11 row_newbcast:4 row_mask:0xf bank_mask:0xf
    s_waitcnt vmcnt(5)
    s_nop 0
    v_mfma_f32_16x16x32_bf16 v[40:43], v[32:35], v[152:155], v[40:43]
    v_and_b32_dpp v36, v58, v8 row_newbcast:12 row_mask:0xf bank_mask:0xf
    v_and_b32_dpp v37, v58, v9 row_newbcast:12 row_mask:0xf bank_mask:0xf
    v_and_b32_dpp v38, v58, v10 row_newbcast:12 row_mask:0xf bank_mask:0xf
    v_and_b32_dpp v39, v58, v11 row_newbcast:12 row_mask:0xf bank_mask:0xf
    s_waitcnt vmcnt(4)
    s_nop 0
    v_mfma_f32_16x16x32_bf16 v[40:43], v[36:39], v[156:159], v[40:43]
    v_and_b32_dpp v32, v59, v8 row_newbcast:0 row_mask:0xf bank_mask:0xf
    v_and_b32_dpp v33, v59, v9 row_newbcast:0 row_mask:0xf bank_mask:0xf
    v_and_b32_dpp v34, v59, v10 row_newbcast:0 row_mask:0xf bank_mask:0xf
    v_and_b32_dpp v35, v59, v11 row_newbcast:0 row_mask:0xf bank_mask:0xf
    s_waitcnt vmcnt(3)
    s_nop 0
    v_mfma_f32_16x16x32_bf16 v[40:43], v[32:35], v[164:167], v[40:43]
    v_and_b32_dpp v36, v59, v8 row_newbcast:8 row_mask:0xf bank_mask:0xf
    v_and_b32_dpp v37, v59, v9 row_newbcast:8 row_mask:0xf bank_mask:0xf
    v_and_b32_dpp v38, v59, v10 row_newbcast:8 row_mask:0xf bank_mask:0xf
    v_and_b32_dpp v39, v59, v11 row_newbcast:8 row_mask:0xf bank_mask:0xf
    s_waitcnt vmcnt(2)
    s_nop 0
    v_mfma_f32_16x16x32_bf16 v[40:43], v[36:39], v[168:171], v[40:43]
    v_and_b32_dpp v32, v59, v8 row_newbcast:4 row_mask:0xf bank_mask:0xf
    v_and_b32_dpp v33, v59, v9 row_newbcast:4 row_mask:0xf bank_mask:0xf
    v_and_b32_dpp v34, v59, v10 row_newbcast:4 row_mask:0xf bank_mask:0xf
    v_and_b32_dpp v35, v59, v11 row_newbcast:4 row_mask:0xf bank_mask:0xf
    s_waitcnt vmcnt(1)
    s_nop 0
    v_mfma_f32_16x16x32_bf16 v[40:43], v[32:35], v[176:179], v[40:43]
    v_and_b32_dpp v36, v59, v8 row_newbcast:12 row_mask:0xf bank_mask:0xf
    v_and_b32_dpp v37, v59, v9 row_newbcast:12 row_mask:0xf bank_mask:0xf
    v_and_b32_dpp v38, v59, v10 row_newbcast:12 row_mask:0xf bank_mask:0xf
    v_and_b32_dpp v39, v59, v11 row_newbcast:12 row_mask:0xf bank_mask:0xf
    s_waitcnt vmcnt(0)
    s_nop 0
    v_mfma_f32_16x16x32_bf16 v[40:43], v[36:39], v[180:183], v[40:43]
    s_nop 7
    v_cvt_pk_bf16_f32 v40, v40, v41
    v_cvt_pk_bf16_f32 v41, v42, v43
    ds_write2_b32 v16, v40, v41 offset0:0 offset1:4
    s_mov_b32 s82, 0
    s_cmp_lg_u32 s3, 0
    s_cbranch_scc1 M_nocons
M_ml:
    v_max_u32 v18, v48, v49
    v_max3_u32 v18, v18, v20, v21
    v_cmp_eq_u32 vcc, -1, v18
    s_add_u32 s82, s82, 1
    s_nop 1
    s_cbranch_vccz M_ml_ok
    s_cmp_ge_u32 s82, 65536
    s_cbranch_scc1 M_ml_ok
    buffer_load_dwordx2 v[48:49], v45, s[48:51], s6 offen sc1
    buffer_load_dwordx2 v[20:21], v45, s[48:51], s27 offen sc1
    s_waitcnt vmcnt(0)
    s_branch M_ml
M_ml_ok:
    v_cmp_gt_i32 vcc, 0, v49
    v_cmp_gt_i32 s[26:27], 0, v21
    v_and_b32 v49, 0x7fffffff, v49
    s_bcnt1_i32_b64 s83, vcc
    s_bcnt1_i32_b64 s26, s[26:27]
    s_add_u32 s83, s83, s26
    s_cmp_gt_u32 s83, 16
    s_cselect_b32 s26, 0x2000, 0
    v_max_f32_dpp v6, v48, v48 quad_perm:[1,0,3,2] row_mask:0xf bank_mask:0xf
    v_sub_f32 v4, v48, v6
    v_mul_f32 v4, 0x3fb8aa3b, v4
    v_exp_f32 v4, v4
    s_nop 0
    v_mul_f32 v5, v49, v4
    s_nop 1
    v_add_f32_dpp v5, v5, v5 quad_perm:[1,0,3,2] row_mask:0xf bank_mask:0xf
    v_rcp_f32 v5, v5
    v_readfirstlane_b32 s4, v47
    s_nop 1
    s_sub_u32 s4, s4, 0
    v_mul_f32 v4, v4, v5
    s_and_b32 s4, s4, 0xff
    s_or_b32 s4, s4, s26
    v_mov_b32 v5, s4
    ds_write_b64 v45, v[4:5] offset:0
M_nocons:
    s_waitcnt lgkmcnt(0)
    s_barrier
    ds_read_b128 v[52:55], v17 offset:1024
    ds_read_b128 v[56:59], v17 offset:1152
    v_and_b32 v5, 0x1f8, v0
    ds_read_b64 v[4:5], v5 offset:0
    s_waitcnt lgkmcnt(2)
    v_smfmac_f32_16x16x64_bf16 v[120:123], v[52:55], v[80:87], v19
    v_smfmac_f32_16x16x64_bf16 v[116:119], v[52:55], v[72:79], v19
    v_smfmac_f32_16x16x64_bf16 v[104:107], v[52:55], v[232:239], v19
    v_smfmac_f32_16x16x64_bf16 v[68:71], v[52:55], v[220:227], v19
    s_waitcnt lgkmcnt(1)
    v_smfmac_f32_16x16x64_bf16 v[120:123], v[56:59], v[108:115], v19
    v_smfmac_f32_16x16x64_bf16 v[116:119], v[56:59], v[208:215], v19
    v_smfmac_f32_16x16x64_bf16 v[104:107], v[56:59], v[196:203], v19
    v_smfmac_f32_16x16x64_bf16 v[68:71], v[56:59], v[184:191], v19
    s_waitcnt lgkmcnt(0)
    v_readfirstlane_b32 s78, v5
    s_nop 1
    s_and_b32 s26, s78, 0x2000
    s_and_b32 s78, s78, 0xff
    s_xor_b32 s79, s79, s26
    v_pk_add_f32 v[120:121], v[120:121], v[122:123]
    v_pk_add_f32 v[116:117], v[116:117], v[118:119]
    v_pk_add_f32 v[104:105], v[104:105], v[106:107]
    v_pk_add_f32 v[68:69], v[68:69], v[70:71]
    v_add_f32 v120, v120, v121
    v_add_f32 v116, v116, v117
    v_add_f32 v104, v104, v105
    v_add_f32 v68, v68, v69
    v_permlane16_swap_b32 v120, v116
    s_nop 0
    v_permlane16_swap_b32 v104, v68
    v_add_f32 v24, v120, v116
    v_add_f32 v25, v104, v68
    s_nop 1
    v_permlane32_swap_b32 v24, v25
    v_add_f32 v24, v24, v25
    v_min_u32 v24, -2, v24
    buffer_store_dword v24, v65, s[48:51], s79 offen sc1
    v_lshrrev_b32 v46, 3, v0
    v_and_b32 v3, 7, v0
    s_cmp_ge_u32 s78, 16
    s_cbranch_scc1 M_end
    v_and_b32 v18, -4, v46
    v_add_u32 v46, v46, v18
    v_lshlrev_b32 v46, 11, v46
    v_lshl_add_u32 v46, v3, 4, v46
    s_and_b32 s5, s79, 0x42000
    s_lshl_b32 s4, s78, 7
    s_add_u32 s5, s5, s4
    v_mov_b32 v180, -1
    v_mov_b32 v181, -1
    v_mov_b32 v182, -1
    v_mov_b32 v183, -1
    buffer_load_dwordx4 v[180:183], v46, s[48:51], s5 offen sc1
    v_lshlrev_b32 v3, 2, v3
    v_bfe_u32 v18, v0, 4, 1
    v_lshl_add_u32 v3, v18, 1, v3
    v_bfe_u32 v18, v0, 5, 1
    v_add_lshl_u32 v3, v3, v18, 5
    v_lshl_add_u32 v3, v7, 2, v3
    v_lshlrev_b32 v6, 4, v1
    v_and_b32 v5, 62, v1
    s_lshl_b32 s24, s63, 11
    s_lshl_b32 s25, s61, 10
    s_add_u32 s24, s24, s25
    s_lshr_b32 s4, s4, 1
    s_add_u32 s24, s24, s4
M_y:
    s_waitcnt vmcnt(1)
    v_max3_u32 v18, v180, v181, v182
    v_max_u32 v18, v18, v183
    v_cmp_eq_u32 vcc, -1, v18
    s_add_u32 s82, s82, 1
    s_nop 1
    s_cbranch_vccz M_y_ok
    s_mov_b64 exec, vcc
    buffer_load_dwordx4 v[180:183], v46, s[48:51], s5 offen sc1
    s_cmp_lt_u32 s82, 65536
    s_cbranch_scc1 M_y
M_y_ok:
    s_mov_b64 exec, -1
    v_mul_f32 v24, v4, v180
    v_mul_f32 v25, v4, v181
    v_mul_f32 v26, v4, v182
    v_mul_f32 v27, v4, v183
    v_permlane32_swap_b32 v24, v25
    s_nop 0
    v_permlane32_swap_b32 v26, v27
    v_add_f32 v24, v24, v25
    v_add_f32 v26, v26, v27
    s_nop 1
    v_permlane16_swap_b32 v24, v26
    v_add_f32 v24, v24, v26
    s_nop 1
    v_add_f32_dpp v24, v24, v24 row_ror:8 row_mask:0xf bank_mask:0xf
    ds_write_b32 v3, v24 offset:7168
    s_cmp_lg_u32 s3, 0
    s_waitcnt lgkmcnt(0)
    s_barrier
    s_cbranch_scc1 M_end
    ds_read_b128 v[24:27], v6 offset:7168
    s_waitcnt lgkmcnt(0)
    v_pk_add_f32 v[24:25], v[24:25], v[26:27]
    v_add_f32 v24, v24, v25
    s_nop 1
    v_add_f32_dpp v24, v24, v24 quad_perm:[1,0,3,2] row_mask:0xf bank_mask:0xf
    v_cvt_pk_bf16_f32 v24, v24, v24
    buffer_store_short v24, v5, s[52:55], s24 offen
M_end:
    s_endpgm
.section .rodata,"a"
.p2align 6
.amdhsa_kernel concat_heads__sliding_block_cached__sliding_block_cached__decode_kernel
  .amdhsa_next_free_vgpr 256
  .amdhsa_next_free_sgpr 102
  .amdhsa_accum_offset 256
  .amdhsa_group_segment_fixed_size 0
  .amdhsa_kernarg_size 104
  .amdhsa_user_sgpr_count 2
  .amdhsa_user_sgpr_kernarg_segment_ptr 1
  .amdhsa_system_sgpr_workgroup_id_x 1
.end_amdhsa_kernel
```
